```python
import torch

def _softmax(x, axis=-1):
    return torch.softmax(x, dim=axis)
def _gelu(x):
    return torch.nn.functional.gelu(x, approximate="tanh")
def _silu(x):
    return torch.nn.functional.silu(x)
def _sigmoid(x):
    return torch.sigmoid(x)
def _layernorm(x, axis=-1, eps=1e-5):
    m = x.mean(dim=axis, keepdim=True)
    v = x.var(dim=axis, keepdim=True, unbiased=False)
    return (x - m) / torch.sqrt(v + eps)
def _scatter_add(tgt, idx, src, axis=0):
    return tgt.clone().index_add_(axis, idx, src)
def _segment_sum(src, seg, n):
    out = torch.zeros((n,) + src.shape[1:], dtype=src.dtype)
    return out.index_add_(0, seg, src)
def _pad(x, pw):
    flat = tuple(v for pair in reversed(pw) for v in pair)
    return torch.nn.functional.pad(x, flat)

kernel_name = 'gated_mix__gqa_block_cached__dense_activation_gelu__decode'

def setup_inputs():

    _w = (lambda a: (lambda t: t.to(torch.bfloat16) if t.is_floating_point() else t)(torch.as_tensor(a)))
    def _A_setup():
        B, Sq, D = 4, 1, 512
        Hq, Hkv, Sk, Dh = 32, 8, 8192, 128
        assert Hq % Hkv == 0, (Hq, Hkv)
        return {
            "x": _w((lambda *s: torch.randn(*s, dtype=torch.bfloat16) * 0.05)(B, Sq, D)),
            "k_cache": _w((lambda *s: torch.randn(*s, dtype=torch.bfloat16) * 6.4)(B, Hkv, Sk, Dh)),
            "v_cache": _w((lambda *s: torch.randn(*s, dtype=torch.bfloat16) * 0.1)(B, Hkv, Sk, Dh)),
            "wq": _w((lambda *s: torch.randn(*s, dtype=torch.bfloat16) * 6.4)(D, Hq * Dh) * (D ** -0.5)),
            "wo": _w((lambda *s: torch.randn(*s, dtype=torch.bfloat16) * 0.1)(Hq * Dh, D) * ((Hq * Dh) ** -0.5)),
        }
    _A_in = _A_setup()

    def _B_setup():
        B, S, D, F = 4, 1, 512, 1792
        return {
            "x": _w((lambda *s: torch.randn(*s, dtype=torch.bfloat16) * 0.05)(B, S, D)),
            "w1": _w((lambda *s: torch.randn(*s, dtype=torch.bfloat16) * 3.2)(D, F) * (D ** -0.5)),
            "b1": _w((lambda *s: torch.randn(*s, dtype=torch.bfloat16) * 3.2)(F) * 0.01),
            "w2": _w((lambda *s: torch.randn(*s, dtype=torch.bfloat16) * 0.05)(F, D) * (F ** -0.5)),
            "b2": _w((lambda *s: torch.randn(*s, dtype=torch.bfloat16) * 0.1)(D) * 0.01),
        }
    _B_in = _B_setup()

    return {
        "A_x": _A_in["x"],
        "A_k_cache": _A_in["k_cache"],
        "A_v_cache": _A_in["v_cache"],
        "A_wq": _A_in["wq"],
        "A_wo": _A_in["wo"],
        "B_x": _B_in["x"],
        "B_w1": _B_in["w1"],
        "B_b1": _B_in["b1"],
        "B_w2": _B_in["w2"],
        "B_b2": _B_in["b2"],
        "gate_w": _w((lambda *s: torch.randn(*s, dtype=torch.bfloat16) * 0.05)(512) * 16.0),
    }

def reference(A_x, A_k_cache, A_v_cache, A_wq, A_wo, B_x, B_w1, B_b1, B_w2, B_b2, gate_w):
    def _A_ref(x, k_cache, v_cache, wq, wo):
        B, Sq, D = x.shape
        Hq, Dh = 32, 128
        Hkv = k_cache.shape[1]
        rep = Hq // Hkv
        q = (lambda x, *d: x.permute(*d))((x @ wq).reshape(B, Sq, Hq, Dh), 0, 2, 1, 3)
        k = (lambda x, n, axis: torch.repeat_interleave(x, n, dim=axis))(k_cache, rep, axis=1)
        v = (lambda x, n, axis: torch.repeat_interleave(x, n, dim=axis))(v_cache, rep, axis=1)
        scores = torch.einsum("bhqd,bhkd->bhqk", q, k) * (Dh ** -0.5)
        p = _softmax(scores, axis=-1)
        o = torch.einsum("bhqk,bhkd->bhqd", p, v)
        return (lambda x, *d: x.permute(*d))(o, 0, 2, 1, 3).reshape(B, Sq, Hq * Dh) @ wo

    def _B_ref(x, w1, b1, w2, b2):
        h = torch.einsum("bsd,df->bsf", x, w1) + b1
        h = _gelu(h)
        return torch.einsum("bsf,fd->bsd", h, w2) + b2

    x = A_x
    g = _sigmoid((x * gate_w).sum(-1, keepdims=True))
    a = _A_ref(x, A_k_cache, A_v_cache, A_wq, A_wo)
    b = _B_ref(x, B_w1, B_b1, B_w2, B_b2)
    return g * a + (1 - g) * b
```

```asm
; @launch grid=(256,1,1) block=(320,1,1) lds=162624
.amdgcn_target "amdgcn-amd-amdhsa--gfx950"
.text
.globl gated_mix__gqa_block_cached__dense_activation_gelu__decode_kernel
.p2align 8
.type gated_mix__gqa_block_cached__dense_activation_gelu__decode_kernel,@function
gated_mix__gqa_block_cached__dense_activation_gelu__decode_kernel:
s_cmp_ge_u32 s2, 256
s_cbranch_scc1 L_END
s_load_dwordx16 s[8:23], s[0:1], 0
s_load_dwordx8 s[24:31], s[0:1], 64
s_load_dwordx4 s[32:35], s[0:1], 96
v_lshrrev_b32 v1, 6, v0
v_and_b32 v2, 63, v0
s_and_b32 s36, s2, 7
s_lshr_b32 s37, s2, 3
v_readfirstlane_b32 s3, v1
s_lshr_b32 s38, s37, 3
s_and_b32 s39, s37, 7
v_lshrrev_b32 v3, 4, v2
v_and_b32 v4, 15, v2
s_cmp_eq_u32 s3, 0
s_cbranch_scc1 L_HELPER
s_sub_u32 s4, s3, 1
v_lshrrev_b32 v27, 3, v2
v_and_b32 v30, 2, v27
v_and_b32 v28, 7, v2
v_xor_b32 v30, v30, v28
v_lshlrev_b32 v30, 4, v30
v_lshl_add_u32 v30, v27, 13, v30
v_xor_b32 v31, 64, v30
v_lshlrev_b32 v222, 4, v2
s_lshl_b32 s68, s38, 2
s_add_u32 s68, s68, s4
s_lshl_b32 s68, s68, 8
s_add_u32 s68, s68, s36
s_lshl_b32 s68, s68, 3
s_add_u32 s68, s68, s39
s_lshl_b32 s68, s68, 7
s_lshl_b32 s6, s4, 12
s_add_u32 m0, s6, 131072
s_lshl_b32 s71, s4, 10
s_mov_b32 s58, 0x400000
s_mov_b32 s59, 0x20000
s_mov_b32 s62, 4096
s_mov_b32 s63, 0x20000
s_mov_b32 s7, 0x10000
s_movk_i32 s69, 1024
s_lshl_b32 s5, s38, 3
s_add_u32 s5, s5, s36
s_lshl_b32 s5, s5, 3
s_add_u32 s5, s5, s39
s_lshl_b32 s5, s5, 18
s_mul_i32 s70, s6, 1
s_add_u32 s5, s5, s70
s_waitcnt lgkmcnt(0)
s_mov_b32 s56, s14
s_mov_b32 s57, s15
buffer_load_dwordx4 v30, s[56:59], s68 offen nt lds
s_add_u32 m0, m0, s69
s_add_u32 s68, s68, s7
buffer_load_dwordx4 v31, s[56:59], s68 offen nt lds
s_add_u32 m0, m0, s69
s_add_u32 s68, s68, s7
buffer_load_dwordx4 v30, s[56:59], s68 offen nt lds
s_add_u32 m0, m0, s69
s_add_u32 s68, s68, s7
buffer_load_dwordx4 v31, s[56:59], s68 offen nt lds
s_mov_b32 s60, s8
s_mov_b32 s61, s9
s_add_u32 m0, s71, 147456
s_nop 0
buffer_load_dwordx4 v222, s[60:63], s71 offen  lds
s_mov_b32 s52, s10
s_mov_b32 s53, s11
s_mov_b32 s54, 0x4000000
s_mov_b32 s55, 0x20000
v_add_u32 v27, 0, v3
v_xor_b32 v27, v27, v4
v_lshlrev_b32 v27, 4, v27
v_lshl_add_u32 v5, v3, 8, v27
v_add_u32 v27, 4, v3
v_xor_b32 v27, v27, v4
v_lshlrev_b32 v27, 4, v27
v_lshl_add_u32 v6, v3, 8, v27
v_add_u32 v27, 8, v3
v_xor_b32 v27, v27, v4
v_lshlrev_b32 v27, 4, v27
v_lshl_add_u32 v7, v3, 8, v27
v_add_u32 v27, 12, v3
v_xor_b32 v27, v27, v4
v_lshlrev_b32 v27, 4, v27
v_lshl_add_u32 v8, v3, 8, v27
s_lshl_b32 s6, s4, 15
s_mov_b32 s7, s5
s_memrealtime s[18:19]
s_barrier
s_mov_b32 m0, s6
s_nop 0
buffer_load_dwordx4 v5, s[52:55], s7 offen offset:0 nt lds
buffer_load_dwordx4 v6, s[52:55], s7 offen offset:1024 nt lds
buffer_load_dwordx4 v7, s[52:55], s7 offen offset:2048 nt lds
buffer_load_dwordx4 v8, s[52:55], s7 offen offset:3072 nt lds
s_add_u32 m0, s6, 4096
s_add_u32 s7, s5, 32768
buffer_load_dwordx4 v5, s[52:55], s7 offen offset:0 nt lds
buffer_load_dwordx4 v6, s[52:55], s7 offen offset:1024 nt lds
buffer_load_dwordx4 v7, s[52:55], s7 offen offset:2048 nt lds
buffer_load_dwordx4 v8, s[52:55], s7 offen offset:3072 nt lds
s_load_dword s44, s[34:35], 0
s_mov_b32 s56, s12
s_mov_b32 s57, s13
s_mov_b32 s58, 0x4000000
s_mov_b32 s59, 0x20000
s_mov_b32 s60, s16
s_mov_b32 s61, s17
s_mov_b32 s62, 0x400000
s_mov_b32 s63, 0x20000
s_mov_b32 s64, s24
s_mov_b32 s65, s25
s_mov_b32 s66, 0x1c0000
s_mov_b32 s67, 0x20000
s_mov_b32 s48, s34
s_mov_b32 s49, s35
s_mov_b32 s50, 0x200000
s_mov_b32 s51, 0x20000
s_lshl_b32 s68, s36, 2
s_add_u32 s40, s68, s38
s_lshl_b32 s46, s40, 2
s_add_u32 s46, s46, s4
s_lshl_b32 s46, s46, 15
s_lshl_b32 s69, s39, 7
s_add_u32 s46, s46, s69
s_mul_i32 s47, s40, 56
s_lshl_b32 s68, s4, 4
s_add_u32 s47, s47, s68
s_lshl_b32 s47, s47, 10
s_add_u32 s47, s47, s69
s_lshl_b32 s68, s40, 3
s_add_u32 s68, s68, s39
s_lshl_b32 s25, s68, 11
s_lshl_b32 s69, s4, 9
s_add_u32 s25, s25, s69
s_add_u32 s25, s25, 1048576
s_lshl_b32 s27, s68, 10
s_lshl_b32 s69, s4, 8
s_add_u32 s27, s27, s69
s_add_u32 s27, s27, 1572864
s_lshl_b32 s69, s4, 7
s_lshl_b32 s26, s36, 16
s_add_u32 s26, s26, s69
s_lshl_b32 s69, s38, 9
s_add_u32 s26, s26, s69
s_add_u32 s26, s26, 1048576
s_add_u32 s28, s26, 4096
s_add_u32 s30, s26, 8192
s_add_u32 s31, s26, 12288
v_add_u32 v27, 0, v3
v_lshlrev_b32 v27, 1, v27
v_xor_b32 v27, v27, v4
v_lshlrev_b32 v27, 4, v27
v_lshl_add_u32 v9, v3, 8, v27
v_add_u32 v27, 4, v3
v_lshlrev_b32 v27, 1, v27
v_xor_b32 v27, v27, v4
v_lshlrev_b32 v27, 4, v27
v_lshl_add_u32 v10, v3, 8, v27
v_lshrrev_b32 v27, 3, v2
v_and_b32 v28, 0x70, v30
v_lshl_add_u32 v11, v27, 10, v28
v_xor_b32 v24, 64, v11
v_xor_b32 v27, v3, v4
v_lshlrev_b32 v27, 4, v27
v_xor_b32 v28, 0, v27
v_lshl_add_u32 v28, v4, 8, v28
v_add_u32 v12, s6, v28
v_xor_b32 v28, 64, v27
v_lshl_add_u32 v28, v4, 8, v28
v_add_u32 v13, s6, v28
v_xor_b32 v28, 128, v27
v_lshl_add_u32 v28, v4, 8, v28
v_add_u32 v14, s6, v28
v_xor_b32 v28, 192, v27
v_lshl_add_u32 v28, v4, 8, v28
v_add_u32 v15, s6, v28
v_lshrrev_b32 v27, 2, v2
v_and_b32 v28, 7, v27
v_lshlrev_b32 v28, 1, v28
v_bfe_u32 v25, v2, 1, 1
v_xor_b32 v28, v28, v25
v_lshlrev_b32 v28, 4, v28
v_and_b32 v25, 1, v2
v_lshl_add_u32 v28, v25, 3, v28
v_lshl_add_u32 v28, v27, 8, v28
v_xor_b32 v25, 0, v28
v_add_u32 v16, s6, v25
v_xor_b32 v25, 32, v28
v_add_u32 v17, s6, v25
v_xor_b32 v25, 64, v28
v_add_u32 v18, s6, v25
v_xor_b32 v25, 96, v28
v_add_u32 v19, s6, v25
v_xor_b32 v25, 128, v28
v_add_u32 v20, s6, v25
v_xor_b32 v25, 160, v28
v_add_u32 v21, s6, v25
v_xor_b32 v25, 192, v28
v_add_u32 v22, s6, v25
v_xor_b32 v25, 224, v28
v_add_u32 v23, s6, v25
s_mov_b32 s43, 0x3e0293ee
v_and_b32 v25, 3, v2
v_bfe_u32 v26, v2, 2, 2
v_lshlrev_b32 v36, 8, v25
v_lshl_add_u32 v36, v3, 4, v36
v_add_u32 v219, 131072, v36
v_add_u32 v36, 152576, v36
s_lshl_b32 s68, s4, 11
s_add_u32 s68, s68, 154432
v_lshlrev_b32 v216, 9, v25
v_lshl_add_u32 v216, v3, 4, v216
v_add_u32 v216, s68, v216
v_lshl_add_u32 v216, v26, 6, v216
s_lshl_b32 s68, s4, 9
s_add_u32 s68, s68, 154432
v_and_b32 v27, 31, v2
v_lshlrev_b32 v27, 4, v27
v_add_u32 v217, s68, v27
v_bfe_u32 v27, v2, 3, 2
v_and_b32 v28, 7, v2
v_lshrrev_b32 v220, 5, v2
v_lshlrev_b32 v220, 11, v220
v_lshl_add_u32 v220, v27, 14, v220
v_lshl_add_u32 v220, v28, 4, v220
s_lshl_b32 s68, s4, 6
s_add_u32 s68, s68, 131072
v_lshlrev_b32 v218, 8, v27
v_lshl_add_u32 v218, v28, 3, v218
v_add_u32 v218, s68, v218
v_lshlrev_b32 v221, 6, v25
v_lshl_add_u32 v221, v3, 4, v221
v_bfe_u32 v27, v2, 3, 2
v_lshlrev_b32 v27, 1, v27
v_bfe_u32 v28, v2, 1, 1
v_xor_b32 v27, v27, v28
s_lshl_b32 s68, s4, 1
v_xor_b32 v27, s68, v27
v_lshlrev_b32 v27, 4, v27
v_and_b32 v28, 1, v2
v_lshl_add_u32 v27, v28, 3, v27
v_lshl_add_u32 v27, v26, 7, v27
v_lshl_add_u32 v224, v3, 10, v27
v_add_u32 v225, 0x10000, v224
v_and_b32 v28, 1, v3
v_lshl_add_u32 v27, v28, 10, v27
v_lshrrev_b32 v28, 1, v3
v_lshl_add_u32 v27, v28, 15, v27
v_add_u32 v226, 4096, v27
v_add_u32 v227, 0x11000, v27
v_lshlrev_b32 v228, 7, v25
v_lshl_add_u32 v228, v3, 4, v228
v_add_u32 v228, 153728, v228
v_lshlrev_b32 v229, 2, v25
v_add_u32 v229, 153664, v229
v_and_b32 v27, 1, v2
v_lshlrev_b32 v27, 4, v27
v_mov_b32 v28, 0x3f80
v_lshlrev_b32 v27, v27, v28
v_and_b32 v28, 1, v3
v_cmp_eq_u32 vcc, v28, v26
s_nop 1
v_cndmask_b32 v27, 0, v27, vcc
v_and_b32 v28, 2, v2
v_cmp_eq_u32 vcc, 0, v28
s_nop 1
v_cndmask_b32 v232, 0, v27, vcc
v_cndmask_b32 v233, v27, 0, vcc
v_mov_b32 v234, v232
v_mov_b32 v235, v233
s_waitcnt lgkmcnt(0)
s_add_u32 s44, s44, 1
s_xor_b32 s45, s44, 0xa5c3e1f0
s_and_b32 s45, s45, -16
v_mov_b32 v34, s44
v_mov_b32 v35, s45
v_mov_b32 v25, 0xff800000
v_mov_b32 v26, 0
s_waitcnt vmcnt(8)
s_barrier
s_waitcnt vmcnt(4)
s_add_u32 m0, s6, 8192
s_add_u32 s7, s5, 65536
buffer_load_dwordx4 v5, s[52:55], s7 offen offset:0 nt lds
s_waitcnt vmcnt(4)
buffer_load_dwordx4 v6, s[52:55], s7 offen offset:1024 nt lds
s_waitcnt vmcnt(4)
buffer_load_dwordx4 v7, s[52:55], s7 offen offset:2048 nt lds
s_waitcnt vmcnt(4)
buffer_load_dwordx4 v8, s[52:55], s7 offen offset:3072 nt lds
s_waitcnt vmcnt(4)
s_add_u32 m0, s6, 12288
s_add_u32 s7, s5, 98304
buffer_load_dwordx4 v5, s[52:55], s7 offen offset:0 nt lds
s_memrealtime s[20:21]
s_waitcnt vmcnt(4)
buffer_load_dwordx4 v6, s[52:55], s7 offen offset:1024 nt lds
s_waitcnt vmcnt(4)
buffer_load_dwordx4 v7, s[52:55], s7 offen offset:2048 nt lds
s_waitcnt vmcnt(4)
buffer_load_dwordx4 v8, s[52:55], s7 offen offset:3072 nt lds
s_waitcnt lgkmcnt(0)
s_sub_u32 s20, s20, s18
s_cmp_gt_u32 s20, 290
s_cselect_b64 vcc, -1, 0
s_add_u32 m0, s6, 16384
s_add_u32 s7, s5, 131072
s_waitcnt vmcnt(5)
s_cbranch_vccnz BO1
s_waitcnt vmcnt(4)
BO1:
buffer_load_dwordx4 v5, s[52:55], s7 offen offset:0 nt lds
s_memrealtime s[20:21]
s_waitcnt vmcnt(5)
s_cbranch_vccnz BO2
s_waitcnt vmcnt(4)
BO2:
buffer_load_dwordx4 v6, s[52:55], s7 offen offset:1024 nt lds
s_waitcnt vmcnt(5)
s_cbranch_vccnz BO3
s_waitcnt vmcnt(4)
BO3:
buffer_load_dwordx4 v7, s[52:55], s7 offen offset:2048 nt lds
s_waitcnt vmcnt(5)
s_cbranch_vccnz BO4
s_waitcnt vmcnt(4)
BO4:
buffer_load_dwordx4 v8, s[52:55], s7 offen offset:3072 nt lds
s_waitcnt lgkmcnt(0)
s_sub_u32 s20, s20, s18
s_cmp_gt_u32 s20, 345
s_cselect_b64 vcc, -1, 0
s_add_u32 m0, s6, 20480
s_add_u32 s7, s5, 163840
s_waitcnt vmcnt(5)
s_cbranch_vccnz BO5
s_waitcnt vmcnt(4)
BO5:
buffer_load_dwordx4 v5, s[52:55], s7 offen offset:0 nt lds
s_memrealtime s[20:21]
s_waitcnt vmcnt(5)
s_cbranch_vccnz BO6
s_waitcnt vmcnt(4)
BO6:
buffer_load_dwordx4 v6, s[52:55], s7 offen offset:1024 nt lds
s_waitcnt vmcnt(5)
s_cbranch_vccnz BO7
s_waitcnt vmcnt(4)
BO7:
buffer_load_dwordx4 v7, s[52:55], s7 offen offset:2048 nt lds
s_waitcnt vmcnt(5)
s_cbranch_vccnz BO8
s_waitcnt vmcnt(4)
BO8:
buffer_load_dwordx4 v8, s[52:55], s7 offen offset:3072 nt lds
s_waitcnt lgkmcnt(0)
s_sub_u32 s20, s20, s18
s_cmp_gt_u32 s20, 400
s_cselect_b64 vcc, -1, 0
s_add_u32 m0, s6, 24576
s_add_u32 s7, s5, 196608
s_waitcnt vmcnt(5)
s_cbranch_vccnz BO9
s_waitcnt vmcnt(4)
BO9:
buffer_load_dwordx4 v5, s[52:55], s7 offen offset:0 nt lds
s_memrealtime s[20:21]
s_waitcnt vmcnt(5)
s_cbranch_vccnz BO10
s_waitcnt vmcnt(4)
BO10:
buffer_load_dwordx4 v6, s[52:55], s7 offen offset:1024 nt lds
s_waitcnt vmcnt(5)
s_cbranch_vccnz BO11
s_waitcnt vmcnt(4)
BO11:
buffer_load_dwordx4 v7, s[52:55], s7 offen offset:2048 nt lds
s_waitcnt vmcnt(5)
s_cbranch_vccnz BO12
s_waitcnt vmcnt(4)
BO12:
buffer_load_dwordx4 v8, s[52:55], s7 offen offset:3072 nt lds
s_waitcnt lgkmcnt(0)
s_sub_u32 s20, s20, s18
s_cmp_gt_u32 s20, 455
s_cselect_b64 vcc, -1, 0
s_add_u32 m0, s6, 28672
s_add_u32 s7, s5, 229376
s_waitcnt vmcnt(5)
s_cbranch_vccnz BO13
s_waitcnt vmcnt(4)
BO13:
buffer_load_dwordx4 v5, s[52:55], s7 offen offset:0 nt lds
s_memrealtime s[20:21]
s_waitcnt vmcnt(5)
s_cbranch_vccnz BO14
s_waitcnt vmcnt(4)
BO14:
buffer_load_dwordx4 v6, s[52:55], s7 offen offset:1024 nt lds
s_waitcnt vmcnt(5)
s_cbranch_vccnz BO15
s_waitcnt vmcnt(4)
BO15:
buffer_load_dwordx4 v7, s[52:55], s7 offen offset:2048 nt lds
s_waitcnt vmcnt(5)
s_cbranch_vccnz BO16
s_waitcnt vmcnt(4)
BO16:
buffer_load_dwordx4 v8, s[52:55], s7 offen offset:3072 nt lds
ds_read_b128 v[56:59], v12 offset:0
ds_read_b128 v[60:63], v13 offset:0
ds_read_b128 v[64:67], v14 offset:0
ds_read_b128 v[68:71], v15 offset:0
s_waitcnt lgkmcnt(0)
s_waitcnt lgkmcnt(0)
s_sub_u32 s20, s20, s18
s_cmp_gt_u32 s20, 510
s_cselect_b64 vcc, -1, 0
s_mov_b32 m0, s6
s_add_u32 s7, s5, 16384
s_waitcnt vmcnt(5)
s_cbranch_vccnz BO17
s_waitcnt vmcnt(4)
BO17:
buffer_load_dwordx4 v5, s[52:55], s7 offen offset:0 nt lds
s_memrealtime s[20:21]
s_waitcnt vmcnt(5)
s_cbranch_vccnz BO18
s_waitcnt vmcnt(4)
BO18:
buffer_load_dwordx4 v6, s[52:55], s7 offen offset:1024 nt lds
s_waitcnt vmcnt(5)
s_cbranch_vccnz BO19
s_waitcnt vmcnt(4)
BO19:
buffer_load_dwordx4 v7, s[52:55], s7 offen offset:2048 nt lds
s_waitcnt vmcnt(5)
s_cbranch_vccnz BO20
s_waitcnt vmcnt(4)
BO20:
buffer_load_dwordx4 v8, s[52:55], s7 offen offset:3072 nt lds
ds_read_b128 v[72:75], v12 offset:4096
ds_read_b128 v[76:79], v13 offset:4096
ds_read_b128 v[80:83], v14 offset:4096
ds_read_b128 v[84:87], v15 offset:4096
s_waitcnt lgkmcnt(0)
s_waitcnt lgkmcnt(0)
s_sub_u32 s20, s20, s18
s_cmp_gt_u32 s20, 565
s_cselect_b64 vcc, -1, 0
s_add_u32 m0, s6, 4096
s_add_u32 s7, s5, 49152
s_waitcnt vmcnt(5)
s_cbranch_vccnz BO21
s_waitcnt vmcnt(4)
BO21:
buffer_load_dwordx4 v5, s[52:55], s7 offen offset:0 nt lds
s_memrealtime s[20:21]
s_waitcnt vmcnt(5)
s_cbranch_vccnz BO22
s_waitcnt vmcnt(4)
BO22:
buffer_load_dwordx4 v6, s[52:55], s7 offen offset:1024 nt lds
s_waitcnt vmcnt(5)
s_cbranch_vccnz BO23
s_waitcnt vmcnt(4)
BO23:
buffer_load_dwordx4 v7, s[52:55], s7 offen offset:2048 nt lds
s_waitcnt vmcnt(5)
s_cbranch_vccnz BO24
s_waitcnt vmcnt(4)
BO24:
buffer_load_dwordx4 v8, s[52:55], s7 offen offset:3072 nt lds
ds_read_b128 v[88:91], v12 offset:8192
ds_read_b128 v[92:95], v13 offset:8192
ds_read_b128 v[96:99], v14 offset:8192
ds_read_b128 v[100:103], v15 offset:8192
s_waitcnt lgkmcnt(0)
s_waitcnt lgkmcnt(0)
s_sub_u32 s20, s20, s18
s_cmp_gt_u32 s20, 620
s_cselect_b64 vcc, -1, 0
s_add_u32 m0, s6, 8192
s_add_u32 s7, s5, 81920
s_waitcnt vmcnt(5)
s_cbranch_vccnz BO25
s_waitcnt vmcnt(4)
BO25:
buffer_load_dwordx4 v5, s[52:55], s7 offen offset:0 nt lds
s_memrealtime s[20:21]
s_waitcnt vmcnt(5)
s_cbranch_vccnz BO26
s_waitcnt vmcnt(4)
BO26:
buffer_load_dwordx4 v6, s[52:55], s7 offen offset:1024 nt lds
s_waitcnt vmcnt(5)
s_cbranch_vccnz BO27
s_waitcnt vmcnt(4)
BO27:
buffer_load_dwordx4 v7, s[52:55], s7 offen offset:2048 nt lds
s_waitcnt vmcnt(5)
s_cbranch_vccnz BO28
s_waitcnt vmcnt(4)
BO28:
buffer_load_dwordx4 v8, s[52:55], s7 offen offset:3072 nt lds
ds_read_b128 v[104:107], v12 offset:12288
ds_read_b128 v[108:111], v13 offset:12288
ds_read_b128 v[112:115], v14 offset:12288
ds_read_b128 v[116:119], v15 offset:12288
s_waitcnt lgkmcnt(0)
s_waitcnt lgkmcnt(0)
s_sub_u32 s20, s20, s18
s_cmp_gt_u32 s20, 675
s_cselect_b64 vcc, -1, 0
s_add_u32 m0, s6, 12288
s_add_u32 s7, s5, 114688
s_waitcnt vmcnt(5)
s_cbranch_vccnz BO29
s_waitcnt vmcnt(4)
BO29:
buffer_load_dwordx4 v5, s[52:55], s7 offen offset:0 nt lds
s_memrealtime s[20:21]
s_waitcnt vmcnt(5)
s_cbranch_vccnz BO30
s_waitcnt vmcnt(4)
BO30:
buffer_load_dwordx4 v6, s[52:55], s7 offen offset:1024 nt lds
s_waitcnt vmcnt(5)
s_cbranch_vccnz BO31
s_waitcnt vmcnt(4)
BO31:
buffer_load_dwordx4 v7, s[52:55], s7 offen offset:2048 nt lds
s_waitcnt vmcnt(5)
s_cbranch_vccnz BO32
s_waitcnt vmcnt(4)
BO32:
buffer_load_dwordx4 v8, s[52:55], s7 offen offset:3072 nt lds
ds_read_b128 v[120:123], v12 offset:16384
ds_read_b128 v[124:127], v13 offset:16384
ds_read_b128 v[128:131], v14 offset:16384
ds_read_b128 v[132:135], v15 offset:16384
s_waitcnt lgkmcnt(0)
s_waitcnt lgkmcnt(0)
s_sub_u32 s20, s20, s18
s_cmp_gt_u32 s20, 730
s_cselect_b64 vcc, -1, 0
s_add_u32 m0, s6, 16384
s_add_u32 s7, s5, 147456
s_waitcnt vmcnt(5)
s_cbranch_vccnz BO33
s_waitcnt vmcnt(4)
BO33:
buffer_load_dwordx4 v5, s[52:55], s7 offen offset:0 nt lds
s_memrealtime s[20:21]
s_waitcnt vmcnt(5)
s_cbranch_vccnz BO34
s_waitcnt vmcnt(4)
BO34:
buffer_load_dwordx4 v6, s[52:55], s7 offen offset:1024 nt lds
s_waitcnt vmcnt(5)
s_cbranch_vccnz BO35
s_waitcnt vmcnt(4)
BO35:
buffer_load_dwordx4 v7, s[52:55], s7 offen offset:2048 nt lds
s_waitcnt vmcnt(5)
s_cbranch_vccnz BO36
s_waitcnt vmcnt(4)
BO36:
buffer_load_dwordx4 v8, s[52:55], s7 offen offset:3072 nt lds
ds_read_b128 v[136:139], v12 offset:20480
ds_read_b128 v[140:143], v13 offset:20480
ds_read_b128 v[144:147], v14 offset:20480
ds_read_b128 v[148:151], v15 offset:20480
s_waitcnt lgkmcnt(0)
s_waitcnt lgkmcnt(0)
s_sub_u32 s20, s20, s18
s_cmp_gt_u32 s20, 785
s_cselect_b64 vcc, -1, 0
s_add_u32 m0, s6, 20480
s_add_u32 s7, s5, 180224
s_waitcnt vmcnt(5)
s_cbranch_vccnz BO37
s_waitcnt vmcnt(4)
BO37:
buffer_load_dwordx4 v5, s[52:55], s7 offen offset:0 nt lds
s_memrealtime s[20:21]
s_waitcnt vmcnt(5)
s_cbranch_vccnz BO38
s_waitcnt vmcnt(4)
BO38:
buffer_load_dwordx4 v6, s[52:55], s7 offen offset:1024 nt lds
s_waitcnt vmcnt(5)
s_cbranch_vccnz BO39
s_waitcnt vmcnt(4)
BO39:
buffer_load_dwordx4 v7, s[52:55], s7 offen offset:2048 nt lds
s_waitcnt vmcnt(5)
s_cbranch_vccnz BO40
s_waitcnt vmcnt(4)
BO40:
buffer_load_dwordx4 v8, s[52:55], s7 offen offset:3072 nt lds
s_mov_b32 s70, 8000000
v_mov_b32 v27, 154368
LW_q:
ds_read_b32 v28, v27 offset:8
s_waitcnt lgkmcnt(0)
v_readfirstlane_b32 s29, v28
s_nop 0
s_cmp_ge_u32 s29, 1
s_cbranch_scc1 LW_q_OK
s_sub_u32 s70, s70, 1
s_cbranch_scc1 LW_q_OK
s_sleep 1
s_branch LW_q
LW_q_OK:
s_sub_u32 s29, s29, 1
ds_read_b128 v[40:43], v36 offset:0
ds_read_b128 v[44:47], v36 offset:64
ds_read_b128 v[48:51], v36 offset:128
ds_read_b128 v[52:55], v36 offset:192
s_waitcnt lgkmcnt(0)
v_mfma_f32_16x16x32_bf16 v[152:155], v[56:59], v[40:43], 0
v_mfma_f32_16x16x32_bf16 v[152:155], v[60:63], v[44:47], v[152:155]
v_mfma_f32_16x16x32_bf16 v[152:155], v[64:67], v[48:51], v[152:155]
v_mfma_f32_16x16x32_bf16 v[152:155], v[68:71], v[52:55], v[152:155]
v_mfma_f32_16x16x32_bf16 v[156:159], v[72:75], v[40:43], 0
v_mfma_f32_16x16x32_bf16 v[156:159], v[76:79], v[44:47], v[156:159]
v_mfma_f32_16x16x32_bf16 v[156:159], v[80:83], v[48:51], v[156:159]
v_mfma_f32_16x16x32_bf16 v[156:159], v[84:87], v[52:55], v[156:159]
ds_read_b128 v[56:59], v12 offset:24576
ds_read_b128 v[60:63], v13 offset:24576
ds_read_b128 v[64:67], v14 offset:24576
ds_read_b128 v[68:71], v15 offset:24576
ds_read_b128 v[72:75], v12 offset:28672
ds_read_b128 v[76:79], v13 offset:28672
ds_read_b128 v[80:83], v14 offset:28672
ds_read_b128 v[84:87], v15 offset:28672
s_waitcnt lgkmcnt(4)
s_waitcnt lgkmcnt(0)
s_sub_u32 s20, s20, s18
s_cmp_gt_u32 s20, 840
s_cselect_b64 vcc, -1, 0
s_add_u32 m0, s6, 24576
s_add_u32 s7, s5, 212992
s_waitcnt vmcnt(5)
s_cbranch_vccnz BO41
s_waitcnt vmcnt(4)
BO41:
buffer_load_dwordx4 v5, s[52:55], s7 offen offset:0 nt lds
s_memrealtime s[20:21]
s_waitcnt vmcnt(5)
v_mfma_f32_16x16x32_bf16 v[160:163], v[88:91], v[40:43], 0
v_mfma_f32_16x16x32_bf16 v[160:163], v[92:95], v[44:47], v[160:163]
v_mfma_f32_16x16x32_bf16 v[160:163], v[96:99], v[48:51], v[160:163]
v_mfma_f32_16x16x32_bf16 v[160:163], v[100:103], v[52:55], v[160:163]
v_max3_f32 v25, v25, v152, v153
v_max3_f32 v25, v25, v154, v155
v_mfma_f32_16x16x32_bf16 v[164:167], v[104:107], v[40:43], 0
v_mfma_f32_16x16x32_bf16 v[164:167], v[108:111], v[44:47], v[164:167]
s_waitcnt vmcnt(5)
s_cbranch_vccnz BO42
s_waitcnt vmcnt(4)
BO42:
buffer_load_dwordx4 v6, s[52:55], s7 offen offset:1024 nt lds
v_mfma_f32_16x16x32_bf16 v[164:167], v[112:115], v[48:51], v[164:167]
v_mfma_f32_16x16x32_bf16 v[164:167], v[116:119], v[52:55], v[164:167]
v_max3_f32 v25, v25, v156, v157
v_max3_f32 v25, v25, v158, v159
v_mfma_f32_16x16x32_bf16 v[168:171], v[120:123], v[40:43], 0
v_mfma_f32_16x16x32_bf16 v[168:171], v[124:127], v[44:47], v[168:171]
v_mfma_f32_16x16x32_bf16 v[168:171], v[128:131], v[48:51], v[168:171]
v_mfma_f32_16x16x32_bf16 v[168:171], v[132:135], v[52:55], v[168:171]
s_waitcnt vmcnt(5)
s_cbranch_vccnz BO43
s_waitcnt vmcnt(4)
BO43:
buffer_load_dwordx4 v7, s[52:55], s7 offen offset:2048 nt lds
v_max3_f32 v25, v25, v160, v161
v_max3_f32 v25, v25, v162, v163
v_mfma_f32_16x16x32_bf16 v[172:175], v[136:139], v[40:43], 0
v_mfma_f32_16x16x32_bf16 v[172:175], v[140:143], v[44:47], v[172:175]
v_mfma_f32_16x16x32_bf16 v[172:175], v[144:147], v[48:51], v[172:175]
v_mfma_f32_16x16x32_bf16 v[172:175], v[148:151], v[52:55], v[172:175]
v_max3_f32 v25, v25, v164, v165
v_max3_f32 v25, v25, v166, v167
s_waitcnt lgkmcnt(4)
v_mfma_f32_16x16x32_bf16 v[176:179], v[56:59], v[40:43], 0
s_waitcnt vmcnt(5)
s_cbranch_vccnz BO44
s_waitcnt vmcnt(4)
BO44:
buffer_load_dwordx4 v8, s[52:55], s7 offen offset:3072 nt lds
v_mfma_f32_16x16x32_bf16 v[176:179], v[60:63], v[44:47], v[176:179]
v_mfma_f32_16x16x32_bf16 v[176:179], v[64:67], v[48:51], v[176:179]
v_mfma_f32_16x16x32_bf16 v[176:179], v[68:71], v[52:55], v[176:179]
v_max3_f32 v25, v25, v168, v169
v_max3_f32 v25, v25, v170, v171
ds_read_b128 v[56:59], v12 offset:0
ds_read_b128 v[60:63], v13 offset:0
ds_read_b128 v[64:67], v14 offset:0
ds_read_b128 v[68:71], v15 offset:0
s_waitcnt lgkmcnt(0)
s_waitcnt lgkmcnt(0)
s_sub_u32 s20, s20, s18
s_cmp_gt_u32 s20, 895
s_cselect_b64 vcc, -1, 0
s_add_u32 m0, s6, 28672
s_add_u32 s7, s5, 245760
s_waitcnt vmcnt(5)
s_cbranch_vccnz BO45
s_waitcnt vmcnt(4)
BO45:
buffer_load_dwordx4 v5, s[52:55], s7 offen offset:0 nt lds
s_memrealtime s[20:21]
s_waitcnt vmcnt(5)
s_waitcnt lgkmcnt(4)
v_mfma_f32_16x16x32_bf16 v[180:183], v[72:75], v[40:43], 0
v_mfma_f32_16x16x32_bf16 v[180:183], v[76:79], v[44:47], v[180:183]
v_mfma_f32_16x16x32_bf16 v[180:183], v[80:83], v[48:51], v[180:183]
v_mfma_f32_16x16x32_bf16 v[180:183], v[84:87], v[52:55], v[180:183]
v_max3_f32 v25, v25, v172, v173
v_max3_f32 v25, v25, v174, v175
ds_read_b128 v[72:75], v12 offset:4096
ds_read_b128 v[76:79], v13 offset:4096
ds_read_b128 v[80:83], v14 offset:4096
ds_read_b128 v[84:87], v15 offset:4096
s_waitcnt lgkmcnt(4)
s_waitcnt vmcnt(5)
s_cbranch_vccnz BO46
s_waitcnt vmcnt(4)
BO46:
buffer_load_dwordx4 v6, s[52:55], s7 offen offset:1024 nt lds
v_mfma_f32_16x16x32_bf16 v[184:187], v[56:59], v[40:43], 0
v_mfma_f32_16x16x32_bf16 v[184:187], v[60:63], v[44:47], v[184:187]
v_mfma_f32_16x16x32_bf16 v[184:187], v[64:67], v[48:51], v[184:187]
v_mfma_f32_16x16x32_bf16 v[184:187], v[68:71], v[52:55], v[184:187]
v_max3_f32 v25, v25, v176, v177
v_max3_f32 v25, v25, v178, v179
ds_read_b128 v[56:59], v12 offset:8192
ds_read_b128 v[60:63], v13 offset:8192
ds_read_b128 v[64:67], v14 offset:8192
ds_read_b128 v[68:71], v15 offset:8192
s_waitcnt lgkmcnt(4)
s_waitcnt vmcnt(5)
s_cbranch_vccnz BO47
s_waitcnt vmcnt(4)
BO47:
buffer_load_dwordx4 v7, s[52:55], s7 offen offset:2048 nt lds
v_mfma_f32_16x16x32_bf16 v[188:191], v[72:75], v[40:43], 0
v_mfma_f32_16x16x32_bf16 v[188:191], v[76:79], v[44:47], v[188:191]
v_mfma_f32_16x16x32_bf16 v[188:191], v[80:83], v[48:51], v[188:191]
v_mfma_f32_16x16x32_bf16 v[188:191], v[84:87], v[52:55], v[188:191]
v_max3_f32 v25, v25, v180, v181
v_max3_f32 v25, v25, v182, v183
ds_read_b128 v[72:75], v12 offset:12288
ds_read_b128 v[76:79], v13 offset:12288
ds_read_b128 v[80:83], v14 offset:12288
ds_read_b128 v[84:87], v15 offset:12288
s_waitcnt lgkmcnt(4)
s_waitcnt vmcnt(5)
s_cbranch_vccnz BO48
s_waitcnt vmcnt(4)
BO48:
buffer_load_dwordx4 v8, s[52:55], s7 offen offset:3072 nt lds
v_mfma_f32_16x16x32_bf16 v[192:195], v[56:59], v[40:43], 0
v_mfma_f32_16x16x32_bf16 v[192:195], v[60:63], v[44:47], v[192:195]
v_mfma_f32_16x16x32_bf16 v[192:195], v[64:67], v[48:51], v[192:195]
v_mfma_f32_16x16x32_bf16 v[192:195], v[68:71], v[52:55], v[192:195]
v_max3_f32 v25, v25, v184, v185
v_max3_f32 v25, v25, v186, v187
ds_read_b128 v[56:59], v12 offset:16384
ds_read_b128 v[60:63], v13 offset:16384
ds_read_b128 v[64:67], v14 offset:16384
ds_read_b128 v[68:71], v15 offset:16384
s_waitcnt lgkmcnt(0)
s_waitcnt lgkmcnt(0)
s_sub_u32 s20, s20, s18
s_cmp_gt_u32 s20, 950
s_cselect_b64 vcc, -1, 0
s_mov_b32 m0, s6
s_add_u32 s7, s5, 0
s_waitcnt vmcnt(5)
s_cbranch_vccnz BO49
s_waitcnt vmcnt(4)
BO49:
buffer_load_dwordx4 v9, s[56:59], s7 offen offset:0 nt lds
s_memrealtime s[20:21]
s_waitcnt vmcnt(5)
s_waitcnt lgkmcnt(4)
v_mfma_f32_16x16x32_bf16 v[196:199], v[72:75], v[40:43], 0
v_mfma_f32_16x16x32_bf16 v[196:199], v[76:79], v[44:47], v[196:199]
v_mfma_f32_16x16x32_bf16 v[196:199], v[80:83], v[48:51], v[196:199]
v_mfma_f32_16x16x32_bf16 v[196:199], v[84:87], v[52:55], v[196:199]
s_waitcnt vmcnt(5)
s_cbranch_vccnz BO50
s_waitcnt vmcnt(4)
BO50:
buffer_load_dwordx4 v10, s[56:59], s7 offen offset:1024 nt lds
v_max3_f32 v25, v25, v188, v189
v_max3_f32 v25, v25, v190, v191
ds_read_b128 v[72:75], v12 offset:20480
ds_read_b128 v[76:79], v13 offset:20480
ds_read_b128 v[80:83], v14 offset:20480
ds_read_b128 v[84:87], v15 offset:20480
s_waitcnt lgkmcnt(4)
s_waitcnt vmcnt(5)
s_cbranch_vccnz BO51
s_waitcnt vmcnt(4)
BO51:
buffer_load_dwordx4 v9, s[56:59], s7 offen offset:2048 nt lds
v_mfma_f32_16x16x32_bf16 v[200:203], v[56:59], v[40:43], 0
v_mfma_f32_16x16x32_bf16 v[200:203], v[60:63], v[44:47], v[200:203]
v_mfma_f32_16x16x32_bf16 v[200:203], v[64:67], v[48:51], v[200:203]
v_mfma_f32_16x16x32_bf16 v[200:203], v[68:71], v[52:55], v[200:203]
s_waitcnt vmcnt(5)
s_cbranch_vccnz BO52
s_waitcnt vmcnt(4)
BO52:
buffer_load_dwordx4 v10, s[56:59], s7 offen offset:3072 nt lds
v_max3_f32 v25, v25, v192, v193
v_max3_f32 v25, v25, v194, v195
ds_read_b128 v[56:59], v12 offset:24576
ds_read_b128 v[60:63], v13 offset:24576
ds_read_b128 v[64:67], v14 offset:24576
ds_read_b128 v[68:71], v15 offset:24576
s_waitcnt lgkmcnt(0)
s_waitcnt lgkmcnt(0)
s_sub_u32 s20, s20, s18
s_cmp_gt_u32 s20, 1005
s_cselect_b64 vcc, -1, 0
s_add_u32 m0, s6, 4096
s_add_u32 s7, s5, 32768
s_waitcnt vmcnt(5)
s_cbranch_vccnz BO53
s_waitcnt vmcnt(4)
BO53:
buffer_load_dwordx4 v9, s[56:59], s7 offen offset:0 nt lds
s_memrealtime s[20:21]
s_waitcnt vmcnt(5)
s_waitcnt lgkmcnt(4)
v_mfma_f32_16x16x32_bf16 v[204:207], v[72:75], v[40:43], 0
v_mfma_f32_16x16x32_bf16 v[204:207], v[76:79], v[44:47], v[204:207]
s_waitcnt vmcnt(5)
s_cbranch_vccnz BO54
s_waitcnt vmcnt(4)
BO54:
buffer_load_dwordx4 v10, s[56:59], s7 offen offset:1024 nt lds
v_mfma_f32_16x16x32_bf16 v[204:207], v[80:83], v[48:51], v[204:207]
v_mfma_f32_16x16x32_bf16 v[204:207], v[84:87], v[52:55], v[204:207]
s_waitcnt vmcnt(5)
s_cbranch_vccnz BO55
s_waitcnt vmcnt(4)
BO55:
buffer_load_dwordx4 v9, s[56:59], s7 offen offset:2048 nt lds
v_max3_f32 v25, v25, v196, v197
v_max3_f32 v25, v25, v198, v199
ds_read_b128 v[72:75], v12 offset:28672
s_waitcnt vmcnt(5)
s_cbranch_vccnz BO56
s_waitcnt vmcnt(4)
BO56:
buffer_load_dwordx4 v10, s[56:59], s7 offen offset:3072 nt lds
ds_read_b128 v[76:79], v13 offset:28672
ds_read_b128 v[80:83], v14 offset:28672
ds_read_b128 v[84:87], v15 offset:28672
s_waitcnt lgkmcnt(0)
s_waitcnt lgkmcnt(0)
s_sub_u32 s20, s20, s18
s_cmp_gt_u32 s20, 1060
s_cselect_b64 vcc, -1, 0
s_add_u32 m0, s6, 8192
s_add_u32 s7, s5, 65536
s_waitcnt vmcnt(5)
s_cbranch_vccnz BO57
s_waitcnt vmcnt(4)
BO57:
buffer_load_dwordx4 v9, s[56:59], s7 offen offset:0 nt lds
s_memrealtime s[20:21]
s_waitcnt vmcnt(5)
s_waitcnt lgkmcnt(4)
v_mfma_f32_16x16x32_bf16 v[208:211], v[56:59], v[40:43], 0
v_mfma_f32_16x16x32_bf16 v[208:211], v[60:63], v[44:47], v[208:211]
v_mfma_f32_16x16x32_bf16 v[208:211], v[64:67], v[48:51], v[208:211]
v_mfma_f32_16x16x32_bf16 v[208:211], v[68:71], v[52:55], v[208:211]
v_max3_f32 v25, v25, v200, v201
v_max3_f32 v25, v25, v202, v203
s_waitcnt lgkmcnt(0)
v_mfma_f32_16x16x32_bf16 v[212:215], v[72:75], v[40:43], 0
v_mfma_f32_16x16x32_bf16 v[212:215], v[76:79], v[44:47], v[212:215]
v_mfma_f32_16x16x32_bf16 v[212:215], v[80:83], v[48:51], v[212:215]
v_mfma_f32_16x16x32_bf16 v[212:215], v[84:87], v[52:55], v[212:215]
v_max3_f32 v25, v25, v204, v205
v_max3_f32 v25, v25, v206, v207
s_waitcnt lgkmcnt(0)
v_max3_f32 v25, v25, v208, v209
s_waitcnt vmcnt(5)
s_cbranch_vccnz BO58
s_waitcnt vmcnt(4)
BO58:
buffer_load_dwordx4 v10, s[56:59], s7 offen offset:1024 nt lds
v_max3_f32 v25, v25, v210, v211
v_max3_f32 v25, v25, v212, v213
v_max3_f32 v25, v25, v214, v215
v_mov_b32 v27, v25
s_nop 1
v_permlane16_swap_b32 v25, v27
v_max_f32 v25, v25, v27
v_mov_b32 v27, v25
s_nop 1
v_permlane32_swap_b32 v25, v27
v_max_f32 v25, v25, v27
v_mul_f32 v25, s43, v25
v_fma_f32 v152, v152, s43, -v25
v_fma_f32 v153, v153, s43, -v25
v_fma_f32 v154, v154, s43, -v25
v_fma_f32 v155, v155, s43, -v25
v_exp_f32 v152, v152
v_exp_f32 v153, v153
v_exp_f32 v154, v154
v_exp_f32 v155, v155
s_waitcnt vmcnt(5)
s_cbranch_vccnz BO59
s_waitcnt vmcnt(4)
BO59:
buffer_load_dwordx4 v9, s[56:59], s7 offen offset:2048 nt lds
v_cvt_pk_bf16_f32 v120, v152, v153
v_cvt_pk_bf16_f32 v121, v154, v155
v_add_f32 v152, v152, v153
v_add_f32 v154, v154, v155
v_add_f32 v26, v26, v152
v_add_f32 v26, v26, v154
v_fma_f32 v156, v156, s43, -v25
v_fma_f32 v157, v157, s43, -v25
v_fma_f32 v158, v158, s43, -v25
v_fma_f32 v159, v159, s43, -v25
v_exp_f32 v156, v156
v_exp_f32 v157, v157
v_exp_f32 v158, v158
v_exp_f32 v159, v159
v_cvt_pk_bf16_f32 v122, v156, v157
v_cvt_pk_bf16_f32 v123, v158, v159
v_add_f32 v156, v156, v157
s_waitcnt vmcnt(5)
s_cbranch_vccnz BO60
s_waitcnt vmcnt(4)
BO60:
buffer_load_dwordx4 v10, s[56:59], s7 offen offset:3072 nt lds
v_add_f32 v158, v158, v159
v_add_f32 v26, v26, v156
v_add_f32 v26, v26, v158
v_fma_f32 v160, v160, s43, -v25
v_fma_f32 v161, v161, s43, -v25
v_fma_f32 v162, v162, s43, -v25
v_fma_f32 v163, v163, s43, -v25
v_exp_f32 v160, v160
v_exp_f32 v161, v161
v_exp_f32 v162, v162
v_exp_f32 v163, v163
v_cvt_pk_bf16_f32 v124, v160, v161
v_cvt_pk_bf16_f32 v125, v162, v163
v_add_f32 v160, v160, v161
v_add_f32 v162, v162, v163
v_add_f32 v26, v26, v160
v_add_f32 v26, v26, v162
s_waitcnt lgkmcnt(0)
s_sub_u32 s20, s20, s18
s_cmp_gt_u32 s20, 1115
s_cselect_b64 vcc, -1, 0
s_add_u32 m0, s6, 12288
s_add_u32 s7, s5, 98304
s_waitcnt vmcnt(5)
s_cbranch_vccnz BO61
s_waitcnt vmcnt(4)
BO61:
buffer_load_dwordx4 v9, s[56:59], s7 offen offset:0 nt lds
s_memrealtime s[20:21]
s_waitcnt vmcnt(5)
v_fma_f32 v164, v164, s43, -v25
v_fma_f32 v165, v165, s43, -v25
v_fma_f32 v166, v166, s43, -v25
v_fma_f32 v167, v167, s43, -v25
v_exp_f32 v164, v164
v_exp_f32 v165, v165
v_exp_f32 v166, v166
v_exp_f32 v167, v167
v_cvt_pk_bf16_f32 v126, v164, v165
v_cvt_pk_bf16_f32 v127, v166, v167
v_add_f32 v164, v164, v165
v_add_f32 v166, v166, v167
v_add_f32 v26, v26, v164
v_add_f32 v26, v26, v166
v_fma_f32 v168, v168, s43, -v25
v_fma_f32 v169, v169, s43, -v25
v_fma_f32 v170, v170, s43, -v25
v_fma_f32 v171, v171, s43, -v25
v_exp_f32 v168, v168
s_waitcnt vmcnt(5)
s_cbranch_vccnz BO62
s_waitcnt vmcnt(4)
BO62:
buffer_load_dwordx4 v10, s[56:59], s7 offen offset:1024 nt lds
v_exp_f32 v169, v169
v_exp_f32 v170, v170
v_exp_f32 v171, v171
v_cvt_pk_bf16_f32 v128, v168, v169
v_cvt_pk_bf16_f32 v129, v170, v171
v_add_f32 v168, v168, v169
v_add_f32 v170, v170, v171
v_add_f32 v26, v26, v168
v_add_f32 v26, v26, v170
v_fma_f32 v172, v172, s43, -v25
v_fma_f32 v173, v173, s43, -v25
v_fma_f32 v174, v174, s43, -v25
v_fma_f32 v175, v175, s43, -v25
v_exp_f32 v172, v172
v_exp_f32 v173, v173
v_exp_f32 v174, v174
s_waitcnt vmcnt(5)
s_cbranch_vccnz BO63
s_waitcnt vmcnt(4)
BO63:
buffer_load_dwordx4 v9, s[56:59], s7 offen offset:2048 nt lds
v_exp_f32 v175, v175
v_cvt_pk_bf16_f32 v130, v172, v173
v_cvt_pk_bf16_f32 v131, v174, v175
v_add_f32 v172, v172, v173
v_add_f32 v174, v174, v175
v_add_f32 v26, v26, v172
v_add_f32 v26, v26, v174
v_fma_f32 v176, v176, s43, -v25
v_fma_f32 v177, v177, s43, -v25
v_fma_f32 v178, v178, s43, -v25
v_fma_f32 v179, v179, s43, -v25
v_exp_f32 v176, v176
v_exp_f32 v177, v177
v_exp_f32 v178, v178
v_exp_f32 v179, v179
v_cvt_pk_bf16_f32 v132, v176, v177
v_cvt_pk_bf16_f32 v133, v178, v179
s_waitcnt vmcnt(5)
s_cbranch_vccnz BO64
s_waitcnt vmcnt(4)
BO64:
buffer_load_dwordx4 v10, s[56:59], s7 offen offset:3072 nt lds
v_add_f32 v176, v176, v177
v_add_f32 v178, v178, v179
v_add_f32 v26, v26, v176
v_add_f32 v26, v26, v178
v_fma_f32 v180, v180, s43, -v25
v_fma_f32 v181, v181, s43, -v25
v_fma_f32 v182, v182, s43, -v25
v_fma_f32 v183, v183, s43, -v25
v_exp_f32 v180, v180
v_exp_f32 v181, v181
v_exp_f32 v182, v182
v_exp_f32 v183, v183
v_cvt_pk_bf16_f32 v134, v180, v181
v_cvt_pk_bf16_f32 v135, v182, v183
v_add_f32 v180, v180, v181
v_add_f32 v182, v182, v183
v_add_f32 v26, v26, v180
v_add_f32 v26, v26, v182
s_waitcnt lgkmcnt(0)
s_sub_u32 s20, s20, s18
s_cmp_gt_u32 s20, 1170
s_cselect_b64 vcc, -1, 0
s_add_u32 m0, s6, 16384
s_add_u32 s7, s5, 131072
s_waitcnt vmcnt(5)
s_cbranch_vccnz BO65
s_waitcnt vmcnt(4)
BO65:
buffer_load_dwordx4 v9, s[56:59], s7 offen offset:0 nt lds
s_memrealtime s[20:21]
s_waitcnt vmcnt(5)
v_fma_f32 v184, v184, s43, -v25
v_fma_f32 v185, v185, s43, -v25
v_fma_f32 v186, v186, s43, -v25
v_fma_f32 v187, v187, s43, -v25
v_exp_f32 v184, v184
v_exp_f32 v185, v185
v_exp_f32 v186, v186
v_exp_f32 v187, v187
v_cvt_pk_bf16_f32 v136, v184, v185
v_cvt_pk_bf16_f32 v137, v186, v187
v_add_f32 v184, v184, v185
v_add_f32 v186, v186, v187
v_add_f32 v26, v26, v184
v_add_f32 v26, v26, v186
v_fma_f32 v188, v188, s43, -v25
v_fma_f32 v189, v189, s43, -v25
v_fma_f32 v190, v190, s43, -v25
v_fma_f32 v191, v191, s43, -v25
v_exp_f32 v188, v188
s_waitcnt vmcnt(5)
s_cbranch_vccnz BO66
s_waitcnt vmcnt(4)
BO66:
buffer_load_dwordx4 v10, s[56:59], s7 offen offset:1024 nt lds
v_exp_f32 v189, v189
v_exp_f32 v190, v190
v_exp_f32 v191, v191
v_cvt_pk_bf16_f32 v138, v188, v189
v_cvt_pk_bf16_f32 v139, v190, v191
v_add_f32 v188, v188, v189
v_add_f32 v190, v190, v191
v_add_f32 v26, v26, v188
v_add_f32 v26, v26, v190
v_fma_f32 v192, v192, s43, -v25
v_fma_f32 v193, v193, s43, -v25
v_fma_f32 v194, v194, s43, -v25
v_fma_f32 v195, v195, s43, -v25
v_exp_f32 v192, v192
v_exp_f32 v193, v193
v_exp_f32 v194, v194
s_waitcnt vmcnt(5)
s_cbranch_vccnz BO67
s_waitcnt vmcnt(4)
BO67:
buffer_load_dwordx4 v9, s[56:59], s7 offen offset:2048 nt lds
v_exp_f32 v195, v195
v_cvt_pk_bf16_f32 v140, v192, v193
v_cvt_pk_bf16_f32 v141, v194, v195
v_add_f32 v192, v192, v193
v_add_f32 v194, v194, v195
v_add_f32 v26, v26, v192
v_add_f32 v26, v26, v194
v_fma_f32 v196, v196, s43, -v25
v_fma_f32 v197, v197, s43, -v25
v_fma_f32 v198, v198, s43, -v25
v_fma_f32 v199, v199, s43, -v25
v_exp_f32 v196, v196
v_exp_f32 v197, v197
v_exp_f32 v198, v198
v_exp_f32 v199, v199
v_cvt_pk_bf16_f32 v142, v196, v197
v_cvt_pk_bf16_f32 v143, v198, v199
s_waitcnt vmcnt(5)
s_cbranch_vccnz BO68
s_waitcnt vmcnt(4)
BO68:
buffer_load_dwordx4 v10, s[56:59], s7 offen offset:3072 nt lds
v_add_f32 v196, v196, v197
v_add_f32 v198, v198, v199
v_add_f32 v26, v26, v196
v_add_f32 v26, v26, v198
v_fma_f32 v200, v200, s43, -v25
v_fma_f32 v201, v201, s43, -v25
v_fma_f32 v202, v202, s43, -v25
v_fma_f32 v203, v203, s43, -v25
v_exp_f32 v200, v200
v_exp_f32 v201, v201
v_exp_f32 v202, v202
v_exp_f32 v203, v203
v_cvt_pk_bf16_f32 v144, v200, v201
v_cvt_pk_bf16_f32 v145, v202, v203
v_add_f32 v200, v200, v201
v_add_f32 v202, v202, v203
v_add_f32 v26, v26, v200
v_add_f32 v26, v26, v202
s_waitcnt lgkmcnt(0)
s_sub_u32 s20, s20, s18
s_cmp_gt_u32 s20, 1225
s_cselect_b64 vcc, -1, 0
s_add_u32 m0, s6, 20480
s_add_u32 s7, s5, 163840
s_waitcnt vmcnt(5)
s_cbranch_vccnz BO69
s_waitcnt vmcnt(4)
BO69:
buffer_load_dwordx4 v9, s[56:59], s7 offen offset:0 nt lds
s_memrealtime s[20:21]
s_waitcnt vmcnt(5)
v_fma_f32 v204, v204, s43, -v25
v_fma_f32 v205, v205, s43, -v25
v_fma_f32 v206, v206, s43, -v25
v_fma_f32 v207, v207, s43, -v25
v_exp_f32 v204, v204
v_exp_f32 v205, v205
v_exp_f32 v206, v206
v_exp_f32 v207, v207
v_cvt_pk_bf16_f32 v146, v204, v205
v_cvt_pk_bf16_f32 v147, v206, v207
v_add_f32 v204, v204, v205
v_add_f32 v206, v206, v207
v_add_f32 v26, v26, v204
v_add_f32 v26, v26, v206
v_fma_f32 v208, v208, s43, -v25
v_fma_f32 v209, v209, s43, -v25
s_waitcnt vmcnt(5)
s_cbranch_vccnz BO70
s_waitcnt vmcnt(4)
BO70:
buffer_load_dwordx4 v10, s[56:59], s7 offen offset:1024 nt lds
v_fma_f32 v210, v210, s43, -v25
v_fma_f32 v211, v211, s43, -v25
v_exp_f32 v208, v208
v_exp_f32 v209, v209
v_exp_f32 v210, v210
v_exp_f32 v211, v211
v_cvt_pk_bf16_f32 v148, v208, v209
v_cvt_pk_bf16_f32 v149, v210, v211
v_add_f32 v208, v208, v209
v_add_f32 v210, v210, v211
v_add_f32 v26, v26, v208
v_add_f32 v26, v26, v210
v_fma_f32 v212, v212, s43, -v25
v_fma_f32 v213, v213, s43, -v25
v_fma_f32 v214, v214, s43, -v25
v_fma_f32 v215, v215, s43, -v25
s_waitcnt vmcnt(5)
s_cbranch_vccnz BO71
s_waitcnt vmcnt(4)
BO71:
buffer_load_dwordx4 v9, s[56:59], s7 offen offset:2048 nt lds
v_exp_f32 v212, v212
v_exp_f32 v213, v213
v_exp_f32 v214, v214
v_exp_f32 v215, v215
v_cvt_pk_bf16_f32 v150, v212, v213
v_cvt_pk_bf16_f32 v151, v214, v215
v_add_f32 v212, v212, v213
v_add_f32 v214, v214, v215
v_add_f32 v26, v26, v212
v_add_f32 v26, v26, v214
v_mov_b32 v27, v26
s_nop 1
v_permlane16_swap_b32 v26, v27
v_add_f32 v26, v26, v27
v_mov_b32 v27, v26
s_nop 1
v_permlane32_swap_b32 v26, v27
s_waitcnt vmcnt(5)
s_cbranch_vccnz BO72
s_waitcnt vmcnt(4)
BO72:
buffer_load_dwordx4 v10, s[56:59], s7 offen offset:3072 nt lds
v_add_f32 v26, v26, v27
v_mov_b32 v28, v25
v_mov_b32 v29, v26
s_lshl_b32 s68, s4, 5
s_add_u32 s68, s68, 154240
v_lshlrev_b32 v27, 3, v2
v_add_u32 v27, s68, v27
s_mov_b64 exec, 15
ds_write_b64 v27, v[28:29]
s_mov_b64 exec, 1
v_mov_b32 v27, 154368
v_mov_b32 v32, 1
ds_add_u32 v27, v32
s_mov_b64 exec, -1
v_bfe_u32 v27, v2, 2, 2
v_cmp_eq_u32 s[72:73], 0, v27
s_nop 1
v_cndmask_b32 v212, 0, -1, s[72:73]
v_cmp_eq_u32 s[72:73], 1, v27
s_nop 1
v_cndmask_b32 v213, 0, -1, s[72:73]
v_cmp_eq_u32 s[72:73], 2, v27
s_nop 1
v_cndmask_b32 v214, 0, -1, s[72:73]
v_cmp_eq_u32 s[72:73], 3, v27
s_nop 1
v_cndmask_b32 v215, 0, -1, s[72:73]
s_waitcnt lgkmcnt(0)
s_sub_u32 s20, s20, s18
s_cmp_gt_u32 s20, 1280
s_cselect_b64 vcc, -1, 0
s_add_u32 m0, s6, 24576
s_add_u32 s7, s5, 196608
s_waitcnt vmcnt(5)
s_cbranch_vccnz BO73
s_waitcnt vmcnt(4)
BO73:
buffer_load_dwordx4 v9, s[56:59], s7 offen offset:0 nt lds
s_memrealtime s[20:21]
s_waitcnt vmcnt(5)
ds_read_b64_tr_b16 v[56:57], v16 offset:0
ds_read_b64_tr_b16 v[58:59], v16 offset:4096
ds_read_b64_tr_b16 v[60:61], v17 offset:0
ds_read_b64_tr_b16 v[62:63], v17 offset:4096
ds_read_b64_tr_b16 v[64:65], v18 offset:0
ds_read_b64_tr_b16 v[66:67], v18 offset:4096
ds_read_b64_tr_b16 v[68:69], v19 offset:0
ds_read_b64_tr_b16 v[70:71], v19 offset:4096
ds_read_b64_tr_b16 v[72:73], v20 offset:0
ds_read_b64_tr_b16 v[74:75], v20 offset:4096
ds_read_b64_tr_b16 v[76:77], v21 offset:0
ds_read_b64_tr_b16 v[78:79], v21 offset:4096
v_and_b32 v152, v212, v120
v_and_b32 v153, v212, v121
v_and_b32 v154, v212, v122
v_and_b32 v155, v212, v123
v_and_b32 v156, v213, v120
v_and_b32 v157, v213, v121
v_and_b32 v158, v213, v122
v_and_b32 v159, v213, v123
v_and_b32 v160, v214, v120
v_and_b32 v161, v214, v121
v_and_b32 v162, v214, v122
v_and_b32 v163, v214, v123
v_and_b32 v164, v215, v120
s_waitcnt vmcnt(5)
s_cbranch_vccnz BO74
s_waitcnt vmcnt(4)
BO74:
buffer_load_dwordx4 v10, s[56:59], s7 offen offset:1024 nt lds
v_and_b32 v165, v215, v121
v_and_b32 v166, v215, v122
v_and_b32 v167, v215, v123
s_waitcnt lgkmcnt(10)
v_mfma_f32_16x16x32_bf16 v[88:91], v[56:59], v[152:155], 0
ds_read_b64_tr_b16 v[80:81], v22 offset:0
ds_read_b64_tr_b16 v[82:83], v22 offset:4096
s_waitcnt lgkmcnt(10)
v_mfma_f32_16x16x32_bf16 v[88:91], v[60:63], v[156:159], v[88:91]
ds_read_b64_tr_b16 v[84:85], v23 offset:0
ds_read_b64_tr_b16 v[86:87], v23 offset:4096
s_waitcnt lgkmcnt(10)
v_mfma_f32_16x16x32_bf16 v[88:91], v[64:67], v[160:163], v[88:91]
s_waitcnt lgkmcnt(8)
v_mfma_f32_16x16x32_bf16 v[88:91], v[68:71], v[164:167], v[88:91]
s_waitcnt lgkmcnt(6)
v_mfma_f32_16x16x32_bf16 v[92:95], v[72:75], v[152:155], 0
s_waitcnt lgkmcnt(4)
v_mfma_f32_16x16x32_bf16 v[92:95], v[76:79], v[156:159], v[92:95]
s_waitcnt lgkmcnt(2)
v_mfma_f32_16x16x32_bf16 v[92:95], v[80:83], v[160:163], v[92:95]
s_waitcnt lgkmcnt(0)
v_mfma_f32_16x16x32_bf16 v[92:95], v[84:87], v[164:167], v[92:95]
s_waitcnt vmcnt(5)
s_cbranch_vccnz BO75
s_waitcnt vmcnt(4)
BO75:
buffer_load_dwordx4 v9, s[56:59], s7 offen offset:2048 nt lds
ds_read_b64_tr_b16 v[56:57], v16 offset:8192
ds_read_b64_tr_b16 v[58:59], v16 offset:12288
ds_read_b64_tr_b16 v[60:61], v17 offset:8192
ds_read_b64_tr_b16 v[62:63], v17 offset:12288
ds_read_b64_tr_b16 v[64:65], v18 offset:8192
ds_read_b64_tr_b16 v[66:67], v18 offset:12288
ds_read_b64_tr_b16 v[68:69], v19 offset:8192
ds_read_b64_tr_b16 v[70:71], v19 offset:12288
ds_read_b64_tr_b16 v[72:73], v20 offset:8192
ds_read_b64_tr_b16 v[74:75], v20 offset:12288
ds_read_b64_tr_b16 v[76:77], v21 offset:8192
ds_read_b64_tr_b16 v[78:79], v21 offset:12288
v_and_b32 v152, v212, v124
v_and_b32 v153, v212, v125
v_and_b32 v154, v212, v126
v_and_b32 v155, v212, v127
v_and_b32 v156, v213, v124
v_and_b32 v157, v213, v125
v_and_b32 v158, v213, v126
v_and_b32 v159, v213, v127
v_and_b32 v160, v214, v124
v_and_b32 v161, v214, v125
v_and_b32 v162, v214, v126
v_and_b32 v163, v214, v127
v_and_b32 v164, v215, v124
s_waitcnt vmcnt(5)
s_cbranch_vccnz BO76
s_waitcnt vmcnt(4)
BO76:
buffer_load_dwordx4 v10, s[56:59], s7 offen offset:3072 nt lds
v_and_b32 v165, v215, v125
v_and_b32 v166, v215, v126
v_and_b32 v167, v215, v127
s_waitcnt lgkmcnt(10)
v_mfma_f32_16x16x32_bf16 v[88:91], v[56:59], v[152:155], v[88:91]
ds_read_b64_tr_b16 v[80:81], v22 offset:8192
ds_read_b64_tr_b16 v[82:83], v22 offset:12288
s_waitcnt lgkmcnt(10)
v_mfma_f32_16x16x32_bf16 v[88:91], v[60:63], v[156:159], v[88:91]
ds_read_b64_tr_b16 v[84:85], v23 offset:8192
ds_read_b64_tr_b16 v[86:87], v23 offset:12288
s_waitcnt lgkmcnt(10)
v_mfma_f32_16x16x32_bf16 v[88:91], v[64:67], v[160:163], v[88:91]
s_waitcnt lgkmcnt(8)
v_mfma_f32_16x16x32_bf16 v[88:91], v[68:71], v[164:167], v[88:91]
s_waitcnt lgkmcnt(6)
v_mfma_f32_16x16x32_bf16 v[92:95], v[72:75], v[152:155], v[92:95]
s_waitcnt lgkmcnt(4)
v_mfma_f32_16x16x32_bf16 v[92:95], v[76:79], v[156:159], v[92:95]
s_waitcnt lgkmcnt(2)
v_mfma_f32_16x16x32_bf16 v[92:95], v[80:83], v[160:163], v[92:95]
s_waitcnt lgkmcnt(0)
v_mfma_f32_16x16x32_bf16 v[92:95], v[84:87], v[164:167], v[92:95]
s_waitcnt lgkmcnt(0)
s_sub_u32 s20, s20, s18
s_cmp_gt_u32 s20, 1335
s_cselect_b64 vcc, -1, 0
s_add_u32 m0, s6, 28672
s_add_u32 s7, s5, 229376
s_waitcnt vmcnt(5)
s_cbranch_vccnz BO77
s_waitcnt vmcnt(4)
BO77:
buffer_load_dwordx4 v9, s[56:59], s7 offen offset:0 nt lds
s_memrealtime s[20:21]
s_waitcnt vmcnt(5)
ds_read_b64_tr_b16 v[56:57], v16 offset:16384
ds_read_b64_tr_b16 v[58:59], v16 offset:20480
ds_read_b64_tr_b16 v[60:61], v17 offset:16384
ds_read_b64_tr_b16 v[62:63], v17 offset:20480
ds_read_b64_tr_b16 v[64:65], v18 offset:16384
ds_read_b64_tr_b16 v[66:67], v18 offset:20480
ds_read_b64_tr_b16 v[68:69], v19 offset:16384
ds_read_b64_tr_b16 v[70:71], v19 offset:20480
ds_read_b64_tr_b16 v[72:73], v20 offset:16384
ds_read_b64_tr_b16 v[74:75], v20 offset:20480
ds_read_b64_tr_b16 v[76:77], v21 offset:16384
ds_read_b64_tr_b16 v[78:79], v21 offset:20480
v_and_b32 v152, v212, v128
s_waitcnt vmcnt(5)
s_cbranch_vccnz BO78
s_waitcnt vmcnt(4)
BO78:
buffer_load_dwordx4 v10, s[56:59], s7 offen offset:1024 nt lds
v_and_b32 v153, v212, v129
v_and_b32 v154, v212, v130
v_and_b32 v155, v212, v131
v_and_b32 v156, v213, v128
v_and_b32 v157, v213, v129
v_and_b32 v158, v213, v130
v_and_b32 v159, v213, v131
v_and_b32 v160, v214, v128
v_and_b32 v161, v214, v129
v_and_b32 v162, v214, v130
v_and_b32 v163, v214, v131
v_and_b32 v164, v215, v128
s_waitcnt vmcnt(5)
s_cbranch_vccnz BO79
s_waitcnt vmcnt(4)
BO79:
buffer_load_dwordx4 v9, s[56:59], s7 offen offset:2048 nt lds
v_and_b32 v165, v215, v129
v_and_b32 v166, v215, v130
v_and_b32 v167, v215, v131
s_waitcnt lgkmcnt(10)
v_mfma_f32_16x16x32_bf16 v[88:91], v[56:59], v[152:155], v[88:91]
ds_read_b64_tr_b16 v[80:81], v22 offset:16384
ds_read_b64_tr_b16 v[82:83], v22 offset:20480
s_waitcnt lgkmcnt(10)
v_mfma_f32_16x16x32_bf16 v[88:91], v[60:63], v[156:159], v[88:91]
ds_read_b64_tr_b16 v[84:85], v23 offset:16384
ds_read_b64_tr_b16 v[86:87], v23 offset:20480
s_waitcnt lgkmcnt(10)
v_mfma_f32_16x16x32_bf16 v[88:91], v[64:67], v[160:163], v[88:91]
s_waitcnt vmcnt(5)
s_cbranch_vccnz BO80
s_waitcnt vmcnt(4)
BO80:
buffer_load_dwordx4 v10, s[56:59], s7 offen offset:3072 nt lds
s_waitcnt lgkmcnt(8)
v_mfma_f32_16x16x32_bf16 v[88:91], v[68:71], v[164:167], v[88:91]
s_waitcnt lgkmcnt(6)
v_mfma_f32_16x16x32_bf16 v[92:95], v[72:75], v[152:155], v[92:95]
s_waitcnt lgkmcnt(4)
v_mfma_f32_16x16x32_bf16 v[92:95], v[76:79], v[156:159], v[92:95]
s_waitcnt lgkmcnt(2)
v_mfma_f32_16x16x32_bf16 v[92:95], v[80:83], v[160:163], v[92:95]
s_waitcnt lgkmcnt(0)
v_mfma_f32_16x16x32_bf16 v[92:95], v[84:87], v[164:167], v[92:95]
s_waitcnt lgkmcnt(0)
s_sub_u32 s20, s20, s18
s_cmp_gt_u32 s20, 1390
s_cselect_b64 vcc, -1, 0
s_mov_b32 m0, s6
s_add_u32 s7, s5, 16384
s_waitcnt vmcnt(5)
s_cbranch_vccnz BO81
s_waitcnt vmcnt(4)
BO81:
buffer_load_dwordx4 v9, s[56:59], s7 offen offset:0 nt lds
s_memrealtime s[20:21]
s_waitcnt vmcnt(5)
s_waitcnt vmcnt(5)
s_cbranch_vccnz BO82
s_waitcnt vmcnt(4)
BO82:
buffer_load_dwordx4 v10, s[56:59], s7 offen offset:1024 nt lds
s_waitcnt vmcnt(5)
s_cbranch_vccnz BO83
s_waitcnt vmcnt(4)
BO83:
buffer_load_dwordx4 v9, s[56:59], s7 offen offset:2048 nt lds
s_waitcnt vmcnt(5)
s_cbranch_vccnz BO84
s_waitcnt vmcnt(4)
BO84:
buffer_load_dwordx4 v10, s[56:59], s7 offen offset:3072 nt lds
s_waitcnt lgkmcnt(0)
s_sub_u32 s20, s20, s18
s_cmp_gt_u32 s20, 1445
s_cselect_b64 vcc, -1, 0
s_add_u32 m0, s6, 4096
s_add_u32 s7, s5, 49152
s_waitcnt vmcnt(5)
s_cbranch_vccnz BO85
s_waitcnt vmcnt(4)
BO85:
buffer_load_dwordx4 v9, s[56:59], s7 offen offset:0 nt lds
s_memrealtime s[20:21]
s_waitcnt vmcnt(5)
ds_read_b64_tr_b16 v[56:57], v16 offset:24576
ds_read_b64_tr_b16 v[58:59], v16 offset:28672
ds_read_b64_tr_b16 v[60:61], v17 offset:24576
ds_read_b64_tr_b16 v[62:63], v17 offset:28672
ds_read_b64_tr_b16 v[64:65], v18 offset:24576
ds_read_b64_tr_b16 v[66:67], v18 offset:28672
ds_read_b64_tr_b16 v[68:69], v19 offset:24576
ds_read_b64_tr_b16 v[70:71], v19 offset:28672
ds_read_b64_tr_b16 v[72:73], v20 offset:24576
ds_read_b64_tr_b16 v[74:75], v20 offset:28672
ds_read_b64_tr_b16 v[76:77], v21 offset:24576
ds_read_b64_tr_b16 v[78:79], v21 offset:28672
v_and_b32 v152, v212, v132
s_waitcnt vmcnt(5)
s_cbranch_vccnz BO86
s_waitcnt vmcnt(4)
BO86:
buffer_load_dwordx4 v10, s[56:59], s7 offen offset:1024 nt lds
v_and_b32 v153, v212, v133
v_and_b32 v154, v212, v134
v_and_b32 v155, v212, v135
v_and_b32 v156, v213, v132
v_and_b32 v157, v213, v133
v_and_b32 v158, v213, v134
v_and_b32 v159, v213, v135
v_and_b32 v160, v214, v132
v_and_b32 v161, v214, v133
v_and_b32 v162, v214, v134
v_and_b32 v163, v214, v135
v_and_b32 v164, v215, v132
s_waitcnt vmcnt(5)
s_cbranch_vccnz BO87
s_waitcnt vmcnt(4)
BO87:
buffer_load_dwordx4 v9, s[56:59], s7 offen offset:2048 nt lds
v_and_b32 v165, v215, v133
v_and_b32 v166, v215, v134
v_and_b32 v167, v215, v135
s_waitcnt lgkmcnt(10)
v_mfma_f32_16x16x32_bf16 v[88:91], v[56:59], v[152:155], v[88:91]
ds_read_b64_tr_b16 v[80:81], v22 offset:24576
ds_read_b64_tr_b16 v[82:83], v22 offset:28672
s_waitcnt lgkmcnt(10)
v_mfma_f32_16x16x32_bf16 v[88:91], v[60:63], v[156:159], v[88:91]
ds_read_b64_tr_b16 v[84:85], v23 offset:24576
ds_read_b64_tr_b16 v[86:87], v23 offset:28672
s_waitcnt lgkmcnt(10)
v_mfma_f32_16x16x32_bf16 v[88:91], v[64:67], v[160:163], v[88:91]
s_waitcnt vmcnt(5)
s_cbranch_vccnz BO88
s_waitcnt vmcnt(4)
BO88:
buffer_load_dwordx4 v10, s[56:59], s7 offen offset:3072 nt lds
s_waitcnt lgkmcnt(8)
v_mfma_f32_16x16x32_bf16 v[88:91], v[68:71], v[164:167], v[88:91]
s_waitcnt lgkmcnt(6)
v_mfma_f32_16x16x32_bf16 v[92:95], v[72:75], v[152:155], v[92:95]
s_waitcnt lgkmcnt(4)
v_mfma_f32_16x16x32_bf16 v[92:95], v[76:79], v[156:159], v[92:95]
s_waitcnt lgkmcnt(2)
v_mfma_f32_16x16x32_bf16 v[92:95], v[80:83], v[160:163], v[92:95]
s_waitcnt lgkmcnt(0)
v_mfma_f32_16x16x32_bf16 v[92:95], v[84:87], v[164:167], v[92:95]
s_waitcnt lgkmcnt(0)
s_sub_u32 s20, s20, s18
s_cmp_gt_u32 s20, 1500
s_cselect_b64 vcc, -1, 0
s_add_u32 m0, s6, 8192
s_add_u32 s7, s5, 81920
s_waitcnt vmcnt(5)
s_cbranch_vccnz BO89
s_waitcnt vmcnt(4)
BO89:
buffer_load_dwordx4 v9, s[56:59], s7 offen offset:0 nt lds
s_memrealtime s[20:21]
s_waitcnt vmcnt(5)
s_mov_b64 exec, 1
v_mov_b32 v27, 154368
v_mov_b32 v32, 1
ds_write_b32 v27, v32 offset:4
s_mov_b64 exec, -1
s_waitcnt vmcnt(5)
s_cbranch_vccnz BO90
s_waitcnt vmcnt(4)
BO90:
buffer_load_dwordx4 v10, s[56:59], s7 offen offset:1024 nt lds
s_waitcnt vmcnt(5)
s_cbranch_vccnz BO91
s_waitcnt vmcnt(4)
BO91:
buffer_load_dwordx4 v9, s[56:59], s7 offen offset:2048 nt lds
s_waitcnt vmcnt(5)
s_cbranch_vccnz BO92
s_waitcnt vmcnt(4)
BO92:
buffer_load_dwordx4 v10, s[56:59], s7 offen offset:3072 nt lds
s_waitcnt lgkmcnt(0)
s_sub_u32 s20, s20, s18
s_cmp_gt_u32 s20, 1555
s_cselect_b64 vcc, -1, 0
s_add_u32 m0, s6, 12288
s_add_u32 s7, s5, 114688
s_waitcnt vmcnt(5)
s_cbranch_vccnz BO93
s_waitcnt vmcnt(4)
BO93:
buffer_load_dwordx4 v9, s[56:59], s7 offen offset:0 nt lds
s_memrealtime s[20:21]
s_waitcnt vmcnt(5)
ds_read_b64_tr_b16 v[56:57], v16 offset:0
ds_read_b64_tr_b16 v[58:59], v16 offset:4096
ds_read_b64_tr_b16 v[60:61], v17 offset:0
ds_read_b64_tr_b16 v[62:63], v17 offset:4096
ds_read_b64_tr_b16 v[64:65], v18 offset:0
ds_read_b64_tr_b16 v[66:67], v18 offset:4096
ds_read_b64_tr_b16 v[68:69], v19 offset:0
ds_read_b64_tr_b16 v[70:71], v19 offset:4096
ds_read_b64_tr_b16 v[72:73], v20 offset:0
ds_read_b64_tr_b16 v[74:75], v20 offset:4096
ds_read_b64_tr_b16 v[76:77], v21 offset:0
ds_read_b64_tr_b16 v[78:79], v21 offset:4096
v_and_b32 v152, v212, v136
s_waitcnt vmcnt(5)
s_cbranch_vccnz BO94
s_waitcnt vmcnt(4)
BO94:
buffer_load_dwordx4 v10, s[56:59], s7 offen offset:1024 nt lds
v_and_b32 v153, v212, v137
v_and_b32 v154, v212, v138
v_and_b32 v155, v212, v139
v_and_b32 v156, v213, v136
v_and_b32 v157, v213, v137
v_and_b32 v158, v213, v138
v_and_b32 v159, v213, v139
v_and_b32 v160, v214, v136
v_and_b32 v161, v214, v137
v_and_b32 v162, v214, v138
v_and_b32 v163, v214, v139
v_and_b32 v164, v215, v136
s_waitcnt vmcnt(5)
s_cbranch_vccnz BO95
s_waitcnt vmcnt(4)
BO95:
buffer_load_dwordx4 v9, s[56:59], s7 offen offset:2048 nt lds
v_and_b32 v165, v215, v137
v_and_b32 v166, v215, v138
v_and_b32 v167, v215, v139
s_waitcnt lgkmcnt(10)
v_mfma_f32_16x16x32_bf16 v[88:91], v[56:59], v[152:155], v[88:91]
ds_read_b64_tr_b16 v[80:81], v22 offset:0
ds_read_b64_tr_b16 v[82:83], v22 offset:4096
s_waitcnt lgkmcnt(10)
v_mfma_f32_16x16x32_bf16 v[88:91], v[60:63], v[156:159], v[88:91]
ds_read_b64_tr_b16 v[84:85], v23 offset:0
ds_read_b64_tr_b16 v[86:87], v23 offset:4096
s_waitcnt lgkmcnt(10)
v_mfma_f32_16x16x32_bf16 v[88:91], v[64:67], v[160:163], v[88:91]
s_waitcnt vmcnt(5)
s_cbranch_vccnz BO96
s_waitcnt vmcnt(4)
BO96:
buffer_load_dwordx4 v10, s[56:59], s7 offen offset:3072 nt lds
s_waitcnt lgkmcnt(8)
v_mfma_f32_16x16x32_bf16 v[88:91], v[68:71], v[164:167], v[88:91]
s_waitcnt lgkmcnt(6)
v_mfma_f32_16x16x32_bf16 v[92:95], v[72:75], v[152:155], v[92:95]
s_waitcnt lgkmcnt(4)
v_mfma_f32_16x16x32_bf16 v[92:95], v[76:79], v[156:159], v[92:95]
s_waitcnt lgkmcnt(2)
v_mfma_f32_16x16x32_bf16 v[92:95], v[80:83], v[160:163], v[92:95]
s_waitcnt lgkmcnt(0)
v_mfma_f32_16x16x32_bf16 v[92:95], v[84:87], v[164:167], v[92:95]
s_waitcnt lgkmcnt(0)
s_sub_u32 s20, s20, s18
s_cmp_gt_u32 s20, 1610
s_cselect_b64 vcc, -1, 0
s_add_u32 m0, s6, 16384
s_add_u32 s7, s5, 147456
s_waitcnt vmcnt(5)
s_cbranch_vccnz BO97
s_waitcnt vmcnt(4)
BO97:
buffer_load_dwordx4 v9, s[56:59], s7 offen offset:0 nt lds
s_memrealtime s[20:21]
s_waitcnt vmcnt(5)
s_waitcnt vmcnt(5)
s_cbranch_vccnz BO98
s_waitcnt vmcnt(4)
BO98:
buffer_load_dwordx4 v10, s[56:59], s7 offen offset:1024 nt lds
s_waitcnt vmcnt(5)
s_cbranch_vccnz BO99
s_waitcnt vmcnt(4)
BO99:
buffer_load_dwordx4 v9, s[56:59], s7 offen offset:2048 nt lds
s_waitcnt vmcnt(5)
s_cbranch_vccnz BO100
s_waitcnt vmcnt(4)
BO100:
buffer_load_dwordx4 v10, s[56:59], s7 offen offset:3072 nt lds
s_waitcnt lgkmcnt(0)
s_sub_u32 s20, s20, s18
s_cmp_gt_u32 s20, 1665
s_cselect_b64 vcc, -1, 0
s_add_u32 m0, s6, 20480
s_add_u32 s7, s5, 180224
s_waitcnt vmcnt(5)
s_cbranch_vccnz BO101
s_waitcnt vmcnt(4)
BO101:
buffer_load_dwordx4 v9, s[56:59], s7 offen offset:0 nt lds
s_memrealtime s[20:21]
s_waitcnt vmcnt(5)
ds_read_b64_tr_b16 v[56:57], v16 offset:8192
ds_read_b64_tr_b16 v[58:59], v16 offset:12288
ds_read_b64_tr_b16 v[60:61], v17 offset:8192
ds_read_b64_tr_b16 v[62:63], v17 offset:12288
ds_read_b64_tr_b16 v[64:65], v18 offset:8192
ds_read_b64_tr_b16 v[66:67], v18 offset:12288
ds_read_b64_tr_b16 v[68:69], v19 offset:8192
ds_read_b64_tr_b16 v[70:71], v19 offset:12288
ds_read_b64_tr_b16 v[72:73], v20 offset:8192
ds_read_b64_tr_b16 v[74:75], v20 offset:12288
ds_read_b64_tr_b16 v[76:77], v21 offset:8192
ds_read_b64_tr_b16 v[78:79], v21 offset:12288
v_and_b32 v152, v212, v140
s_waitcnt vmcnt(5)
s_cbranch_vccnz BO102
s_waitcnt vmcnt(4)
BO102:
buffer_load_dwordx4 v10, s[56:59], s7 offen offset:1024 nt lds
v_and_b32 v153, v212, v141
v_and_b32 v154, v212, v142
v_and_b32 v155, v212, v143
v_and_b32 v156, v213, v140
v_and_b32 v157, v213, v141
v_and_b32 v158, v213, v142
v_and_b32 v159, v213, v143
v_and_b32 v160, v214, v140
v_and_b32 v161, v214, v141
v_and_b32 v162, v214, v142
v_and_b32 v163, v214, v143
v_and_b32 v164, v215, v140
s_waitcnt vmcnt(5)
s_cbranch_vccnz BO103
s_waitcnt vmcnt(4)
BO103:
buffer_load_dwordx4 v9, s[56:59], s7 offen offset:2048 nt lds
v_and_b32 v165, v215, v141
v_and_b32 v166, v215, v142
v_and_b32 v167, v215, v143
s_waitcnt lgkmcnt(10)
v_mfma_f32_16x16x32_bf16 v[88:91], v[56:59], v[152:155], v[88:91]
ds_read_b64_tr_b16 v[80:81], v22 offset:8192
ds_read_b64_tr_b16 v[82:83], v22 offset:12288
s_waitcnt lgkmcnt(10)
v_mfma_f32_16x16x32_bf16 v[88:91], v[60:63], v[156:159], v[88:91]
ds_read_b64_tr_b16 v[84:85], v23 offset:8192
ds_read_b64_tr_b16 v[86:87], v23 offset:12288
s_waitcnt lgkmcnt(10)
v_mfma_f32_16x16x32_bf16 v[88:91], v[64:67], v[160:163], v[88:91]
s_waitcnt vmcnt(5)
s_cbranch_vccnz BO104
s_waitcnt vmcnt(4)
BO104:
buffer_load_dwordx4 v10, s[56:59], s7 offen offset:3072 nt lds
s_waitcnt lgkmcnt(8)
v_mfma_f32_16x16x32_bf16 v[88:91], v[68:71], v[164:167], v[88:91]
s_waitcnt lgkmcnt(6)
v_mfma_f32_16x16x32_bf16 v[92:95], v[72:75], v[152:155], v[92:95]
s_waitcnt lgkmcnt(4)
v_mfma_f32_16x16x32_bf16 v[92:95], v[76:79], v[156:159], v[92:95]
s_waitcnt lgkmcnt(2)
v_mfma_f32_16x16x32_bf16 v[92:95], v[80:83], v[160:163], v[92:95]
s_waitcnt lgkmcnt(0)
v_mfma_f32_16x16x32_bf16 v[92:95], v[84:87], v[164:167], v[92:95]
s_waitcnt lgkmcnt(0)
s_sub_u32 s20, s20, s18
s_cmp_gt_u32 s20, 1720
s_cselect_b64 vcc, -1, 0
s_add_u32 m0, s6, 24576
s_add_u32 s7, s5, 212992
s_waitcnt vmcnt(5)
s_cbranch_vccnz BO105
s_waitcnt vmcnt(4)
BO105:
buffer_load_dwordx4 v9, s[56:59], s7 offen offset:0 nt lds
s_memrealtime s[20:21]
s_waitcnt vmcnt(5)
s_waitcnt vmcnt(5)
s_cbranch_vccnz BO106
s_waitcnt vmcnt(4)
BO106:
buffer_load_dwordx4 v10, s[56:59], s7 offen offset:1024 nt lds
s_waitcnt vmcnt(5)
s_cbranch_vccnz BO107
s_waitcnt vmcnt(4)
BO107:
buffer_load_dwordx4 v9, s[56:59], s7 offen offset:2048 nt lds
s_waitcnt vmcnt(5)
s_cbranch_vccnz BO108
s_waitcnt vmcnt(4)
BO108:
buffer_load_dwordx4 v10, s[56:59], s7 offen offset:3072 nt lds
s_waitcnt lgkmcnt(0)
s_sub_u32 s20, s20, s18
s_cmp_gt_u32 s20, 1775
s_cselect_b64 vcc, -1, 0
s_add_u32 m0, s6, 28672
s_add_u32 s7, s5, 245760
s_waitcnt vmcnt(5)
s_cbranch_vccnz BO109
s_waitcnt vmcnt(4)
BO109:
buffer_load_dwordx4 v9, s[56:59], s7 offen offset:0 nt lds
s_waitcnt vmcnt(5)
ds_read_b64_tr_b16 v[56:57], v16 offset:16384
ds_read_b64_tr_b16 v[58:59], v16 offset:20480
ds_read_b64_tr_b16 v[60:61], v17 offset:16384
ds_read_b64_tr_b16 v[62:63], v17 offset:20480
ds_read_b64_tr_b16 v[64:65], v18 offset:16384
ds_read_b64_tr_b16 v[66:67], v18 offset:20480
ds_read_b64_tr_b16 v[68:69], v19 offset:16384
ds_read_b64_tr_b16 v[70:71], v19 offset:20480
ds_read_b64_tr_b16 v[72:73], v20 offset:16384
ds_read_b64_tr_b16 v[74:75], v20 offset:20480
ds_read_b64_tr_b16 v[76:77], v21 offset:16384
ds_read_b64_tr_b16 v[78:79], v21 offset:20480
v_and_b32 v152, v212, v144
s_waitcnt vmcnt(5)
s_cbranch_vccnz BO110
s_waitcnt vmcnt(4)
BO110:
buffer_load_dwordx4 v10, s[56:59], s7 offen offset:1024 nt lds
v_and_b32 v153, v212, v145
v_and_b32 v154, v212, v146
v_and_b32 v155, v212, v147
v_and_b32 v156, v213, v144
v_and_b32 v157, v213, v145
v_and_b32 v158, v213, v146
v_and_b32 v159, v213, v147
v_and_b32 v160, v214, v144
v_and_b32 v161, v214, v145
v_and_b32 v162, v214, v146
v_and_b32 v163, v214, v147
v_and_b32 v164, v215, v144
s_waitcnt vmcnt(5)
s_cbranch_vccnz BO111
s_waitcnt vmcnt(4)
BO111:
buffer_load_dwordx4 v9, s[56:59], s7 offen offset:2048 nt lds
v_and_b32 v165, v215, v145
v_and_b32 v166, v215, v146
v_and_b32 v167, v215, v147
s_waitcnt lgkmcnt(10)
v_mfma_f32_16x16x32_bf16 v[88:91], v[56:59], v[152:155], v[88:91]
ds_read_b64_tr_b16 v[80:81], v22 offset:16384
ds_read_b64_tr_b16 v[82:83], v22 offset:20480
s_waitcnt lgkmcnt(10)
v_mfma_f32_16x16x32_bf16 v[88:91], v[60:63], v[156:159], v[88:91]
ds_read_b64_tr_b16 v[84:85], v23 offset:16384
ds_read_b64_tr_b16 v[86:87], v23 offset:20480
s_waitcnt lgkmcnt(10)
v_mfma_f32_16x16x32_bf16 v[88:91], v[64:67], v[160:163], v[88:91]
s_waitcnt vmcnt(5)
s_cbranch_vccnz BO112
s_waitcnt vmcnt(4)
BO112:
buffer_load_dwordx4 v10, s[56:59], s7 offen offset:3072 nt lds
s_waitcnt lgkmcnt(8)
v_mfma_f32_16x16x32_bf16 v[88:91], v[68:71], v[164:167], v[88:91]
s_waitcnt lgkmcnt(6)
v_mfma_f32_16x16x32_bf16 v[92:95], v[72:75], v[152:155], v[92:95]
s_waitcnt lgkmcnt(4)
v_mfma_f32_16x16x32_bf16 v[92:95], v[76:79], v[156:159], v[92:95]
s_waitcnt lgkmcnt(2)
v_mfma_f32_16x16x32_bf16 v[92:95], v[80:83], v[160:163], v[92:95]
s_waitcnt lgkmcnt(0)
v_mfma_f32_16x16x32_bf16 v[92:95], v[84:87], v[164:167], v[92:95]
s_lshl_b32 s68, s4, 4
s_add_u32 s68, s68, 153600
v_mov_b32 v30, s68
v_and_b32 v152, v212, v148
v_and_b32 v153, v212, v149
v_and_b32 v154, v212, v150
v_and_b32 v155, v212, v151
v_and_b32 v156, v213, v148
v_and_b32 v157, v213, v149
v_and_b32 v158, v213, v150
v_and_b32 v159, v213, v151
v_and_b32 v160, v214, v148
v_and_b32 v161, v214, v149
v_and_b32 v162, v214, v150
v_and_b32 v163, v214, v151
v_and_b32 v164, v215, v148
v_and_b32 v165, v215, v149
v_and_b32 v166, v215, v150
v_and_b32 v167, v215, v151
s_waitcnt vmcnt(4)
ds_read_b64_tr_b16 v[56:57], v16 offset:24576
ds_read_b64_tr_b16 v[60:61], v17 offset:24576
ds_read_b64_tr_b16 v[64:65], v18 offset:24576
ds_read_b64_tr_b16 v[68:69], v19 offset:24576
ds_read_b64_tr_b16 v[72:73], v20 offset:24576
ds_read_b64_tr_b16 v[76:77], v21 offset:24576
ds_read_b64_tr_b16 v[80:81], v22 offset:24576
ds_read_b64_tr_b16 v[84:85], v23 offset:24576
s_waitcnt vmcnt(2)
s_mov_b32 m0, s6
s_nop 0
buffer_load_dwordx4 v11, s[60:63], s46 offen nt lds
s_add_u32 m0, s6, 1024
s_add_u32 s46, s46, 8192
buffer_load_dwordx4 v24, s[60:63], s46 offen nt lds
s_add_u32 m0, s6, 2048
s_add_u32 s46, s46, 8192
buffer_load_dwordx4 v11, s[60:63], s46 offen nt lds
s_add_u32 m0, s6, 3072
s_add_u32 s46, s46, 8192
buffer_load_dwordx4 v24, s[60:63], s46 offen nt lds
s_add_u32 m0, s6, 4096
s_nop 0
buffer_load_dwordx4 v11, s[64:67], s47 offen nt lds
s_add_u32 m0, s6, 5120
s_add_u32 s47, s47, 8192
buffer_load_dwordx4 v24, s[64:67], s47 offen nt lds
s_waitcnt vmcnt(6)
ds_read_b64_tr_b16 v[58:59], v16 offset:28672
ds_read_b64_tr_b16 v[62:63], v17 offset:28672
ds_read_b64_tr_b16 v[66:67], v18 offset:28672
ds_read_b64_tr_b16 v[70:71], v19 offset:28672
ds_read_b64_tr_b16 v[74:75], v20 offset:28672
ds_read_b64_tr_b16 v[78:79], v21 offset:28672
ds_read_b64_tr_b16 v[82:83], v22 offset:28672
ds_read_b64_tr_b16 v[86:87], v23 offset:28672
s_waitcnt lgkmcnt(7)
v_mfma_f32_16x16x32_bf16 v[88:91], v[56:59], v[152:155], v[88:91]
s_waitcnt lgkmcnt(6)
v_mfma_f32_16x16x32_bf16 v[88:91], v[60:63], v[156:159], v[88:91]
s_waitcnt lgkmcnt(5)
v_mfma_f32_16x16x32_bf16 v[88:91], v[64:67], v[160:163], v[88:91]
s_waitcnt lgkmcnt(4)
v_mfma_f32_16x16x32_bf16 v[88:91], v[68:71], v[164:167], v[88:91]
s_waitcnt lgkmcnt(3)
v_mfma_f32_16x16x32_bf16 v[92:95], v[72:75], v[152:155], v[92:95]
s_waitcnt lgkmcnt(2)
v_mfma_f32_16x16x32_bf16 v[92:95], v[76:79], v[156:159], v[92:95]
s_waitcnt lgkmcnt(1)
v_mfma_f32_16x16x32_bf16 v[92:95], v[80:83], v[160:163], v[92:95]
s_waitcnt lgkmcnt(0)
v_mfma_f32_16x16x32_bf16 v[92:95], v[84:87], v[164:167], v[92:95]
ds_write_b128 v216, v[88:91] offset:0
s_nop 6
ds_write_b128 v216, v[92:95] offset:256
s_waitcnt lgkmcnt(0)
s_barrier
ds_read_b128 v[120:123], v30
ds_read_b128 v[40:43], v217 offset:0
ds_read_b128 v[44:47], v217 offset:2048
ds_read_b128 v[48:51], v217 offset:4096
ds_read_b128 v[52:55], v217 offset:6144
s_waitcnt lgkmcnt(3)
v_pk_mul_f32 v[124:125], v[40:41], v[120:121] op_sel:[0,0] op_sel_hi:[1,0]
v_pk_mul_f32 v[126:127], v[42:43], v[120:121] op_sel:[0,0] op_sel_hi:[1,0]
s_waitcnt lgkmcnt(2)
v_pk_fma_f32 v[124:125], v[44:45], v[120:121], v[124:125] op_sel:[0,1,0] op_sel_hi:[1,1,1]
v_pk_fma_f32 v[126:127], v[46:47], v[120:121], v[126:127] op_sel:[0,1,0] op_sel_hi:[1,1,1]
s_waitcnt lgkmcnt(1)
v_pk_fma_f32 v[124:125], v[48:49], v[122:123], v[124:125] op_sel:[0,0,0] op_sel_hi:[1,0,1]
v_pk_fma_f32 v[126:127], v[50:51], v[122:123], v[126:127] op_sel:[0,0,0] op_sel_hi:[1,0,1]
s_waitcnt lgkmcnt(0)
v_pk_fma_f32 v[124:125], v[52:53], v[122:123], v[124:125] op_sel:[0,1,0] op_sel_hi:[1,1,1]
v_pk_fma_f32 v[126:127], v[54:55], v[122:123], v[126:127] op_sel:[0,1,0] op_sel_hi:[1,1,1]
v_cvt_pk_bf16_f32 v32, v124, v125
v_cvt_pk_bf16_f32 v33, v126, v127
s_mov_b32 exec_hi, 0
s_cmp_lg_u32 s29, 0
s_cbranch_scc1 PUB113_L
buffer_store_dwordx4 v[32:35], v222, s[48:51], s25 offen sc1
s_branch PUB113_E
PUB113_L:
buffer_store_dwordx4 v[32:35], v222, s[48:51], s25 offen
PUB113_E:
s_mov_b32 exec_hi, -1
ds_read_b128 v[40:43], v228
ds_read_b128 v[44:47], v228 offset:64
ds_read_b32 v48, v229
s_waitcnt vmcnt(0)
s_barrier
s_mov_b32 s70, 2000000
buffer_load_dwordx4 v[168:171], v220, s[48:51], s26 offen sc1
buffer_load_dwordx4 v[172:175], v220, s[48:51], s28 offen sc1
buffer_load_dwordx4 v[176:179], v220, s[48:51], s30 offen sc1
buffer_load_dwordx4 v[180:183], v220, s[48:51], s31 offen sc1
ds_read_b64_tr_b16 v[56:57], v226 offset:0
ds_read_b64_tr_b16 v[58:59], v226 offset:512
ds_read_b64_tr_b16 v[60:61], v227 offset:0
ds_read_b64_tr_b16 v[62:63], v227 offset:512
ds_read_b64_tr_b16 v[72:73], v224 offset:0
ds_read_b64_tr_b16 v[74:75], v224 offset:512
ds_read_b64_tr_b16 v[76:77], v224 offset:32768
ds_read_b64_tr_b16 v[78:79], v224 offset:33280
ds_read_b64_tr_b16 v[80:81], v225 offset:0
ds_read_b64_tr_b16 v[82:83], v225 offset:512
ds_read_b64_tr_b16 v[84:85], v225 offset:32768
ds_read_b64_tr_b16 v[86:87], v225 offset:33280
s_waitcnt lgkmcnt(8)
v_mfma_f32_16x16x32_bf16 v[152:155], v[56:59], v[40:43], 0
v_mfma_f32_16x16x32_bf16 v[152:155], v[60:63], v[44:47], v[152:155]
s_nop 7
v_mul_f32 v152, v152, v48
v_mul_f32 v153, v153, v48
v_mul_f32 v154, v154, v48
v_mul_f32 v155, v155, v48
s_branch POLL_o1_CHK
POLL_o1:
buffer_load_dwordx4 v[168:171], v220, s[48:51], s26 offen sc1
buffer_load_dwordx4 v[172:175], v220, s[48:51], s28 offen sc1
buffer_load_dwordx4 v[176:179], v220, s[48:51], s30 offen sc1
buffer_load_dwordx4 v[180:183], v220, s[48:51], s31 offen sc1
POLL_o1_CHK:
s_waitcnt vmcnt(0)
v_cmp_ne_u64 vcc, s[44:45], v[170:171]
v_cmp_ne_u64 s[72:73], s[44:45], v[174:175]
v_cmp_ne_u64 s[8:9], s[44:45], v[178:179]
v_cmp_ne_u64 s[10:11], s[44:45], v[182:183]
s_or_b64 s[72:73], s[72:73], vcc
s_or_b64 s[8:9], s[8:9], s[10:11]
s_or_b64 s[72:73], s[72:73], s[8:9]
s_cbranch_scc0 POLL_o1_OK
s_sub_u32 s70, s70, 1
s_cbranch_scc1 POLL_o1_OK
s_branch POLL_o1
POLL_o1_OK:
v_mov_b32 v170, v172
v_mov_b32 v171, v173
v_mov_b32 v178, v180
v_mov_b32 v179, v181
v_mfma_f32_16x16x32_bf16 v[184:187], v[232:235], v[168:171], 0
s_nop 0
v_mfma_f32_16x16x32_bf16 v[184:187], v[232:235], v[176:179], v[184:187]
s_mov_b32 exec_hi, 0
s_nop 6
v_cvt_pk_bf16_f32 v184, v184, v185
v_cvt_pk_bf16_f32 v185, v186, v187
ds_write_b64 v218, v[184:185]
s_mov_b32 exec_hi, -1
s_waitcnt lgkmcnt(0)
s_barrier
ds_read_b128 v[168:171], v219 offset:0
ds_read_b128 v[172:175], v219 offset:64
ds_read_b128 v[176:179], v219 offset:128
ds_read_b128 v[180:183], v219 offset:192
s_waitcnt lgkmcnt(3)
v_mfma_f32_16x16x32_bf16 v[152:155], v[72:75], v[168:171], v[152:155]
s_waitcnt lgkmcnt(2)
v_mfma_f32_16x16x32_bf16 v[152:155], v[76:79], v[172:175], v[152:155]
s_waitcnt lgkmcnt(1)
v_mfma_f32_16x16x32_bf16 v[152:155], v[80:83], v[176:179], v[152:155]
s_waitcnt lgkmcnt(0)
v_mfma_f32_16x16x32_bf16 v[152:155], v[84:87], v[180:183], v[152:155]
s_mov_b32 exec_lo, 0x000f000f
s_mov_b32 exec_hi, 0x000f000f
s_nop 5
v_cvt_pk_bf16_f32 v32, v152, v153
v_cvt_pk_bf16_f32 v33, v154, v155
buffer_store_dwordx4 v[32:35], v221, s[48:51], s27 offen sc1
s_mov_b64 exec, -1
s_endpgm
L_HELPER:
v_lshlrev_b32 v6, 4, v2
v_and_b32 v7, 3, v2
v_mov_b32 v10, 154368
v_mov_b32 v24, 0
v_mov_b32 v25, 0
v_mov_b32 v26, 0
ds_write_b96 v10, v[24:26]
v_lshrrev_b32 v8, 2, v2
v_mul_u32_u24 v8, 3584, v8
v_lshl_add_u32 v43, v7, 4, v8
s_mul_i32 s68, s36, 448
s_lshl_b32 s69, s39, 6
s_add_u32 s68, s68, s69
s_mul_i32 s69, s38, 458752
s_add_u32 s41, s68, s69
s_lshl_b32 s40, s36, 2
s_add_u32 s40, s40, s38
s_lshl_b32 s7, s36, 7
s_lshl_b32 s69, s38, 5
s_add_u32 s7, s7, s69
s_and_b32 s69, s37, 1
s_lshl_b32 s69, s69, 4
s_add_u32 s7, s7, s69
s_bfe_u32 s42, s37, 0x20001
v_and_b32 v40, 1, v2
v_lshlrev_b32 v40, 3, v40
v_add_u32 v40, s7, v40
v_min_u32 v42, 13, v4
s_mul_i32 s69, s40, 112
v_lshlrev_b32 v9, 3, v42
v_add_u32 v208, s69, v9
s_mov_b32 m0, 154432
s_waitcnt lgkmcnt(0)
s_load_dword s44, s[34:35], 0
s_mov_b32 s56, s20
s_mov_b32 s57, s21
s_mov_b32 s58, 0x1c0000
s_mov_b32 s59, 0x20000
s_mov_b32 s64, s28
s_mov_b32 s65, s29
s_mov_b32 s66, 0x400
s_mov_b32 s67, 0x20000
s_barrier
s_mov_b32 s48, s34
s_mov_b32 s49, s35
s_mov_b32 s50, 0x200000
s_mov_b32 s51, 0x20000
v_lshlrev_b32 v11, 10, v7
v_lshl_add_u32 v11, v3, 4, v11
v_add_u32 v11, 147456, v11
s_lshl_b32 s68, s38, 8
v_add_u32 v12, s68, v11
v_bfe_u32 v8, v2, 2, 2
v_lshl_add_u32 v8, v3, 3, v8
v_lshlrev_b32 v41, 6, v8
v_lshl_add_u32 v41, v7, 3, v41
v_add_u32 v41, 154432, v41
v_bfe_u32 v9, v2, 3, 2
v_lshlrev_b32 v9, 1, v9
v_bfe_u32 v10, v2, 1, 1
v_xor_b32 v9, v9, v10
v_lshlrev_b32 v9, 4, v9
v_and_b32 v10, 1, v2
v_lshl_add_u32 v9, v10, 3, v9
v_lshl_add_u32 v9, v8, 7, v9
v_xor_b32 v20, 0, v9
v_add_u32 v20, 131072, v20
v_xor_b32 v21, 32, v9
v_add_u32 v21, 131072, v21
v_xor_b32 v22, 64, v9
v_add_u32 v22, 131072, v22
v_xor_b32 v23, 96, v9
v_add_u32 v23, 131072, v23
v_lshlrev_b32 v13, 4, v3
v_add_u32 v13, 151552, v13
v_bfe_u32 v8, v2, 2, 2
v_lshlrev_b32 v8, 6, v8
v_lshl_add_u32 v8, v3, 4, v8
v_lshl_add_u32 v19, v7, 16, v8
v_mul_u32_u24 v9, 896, v7
v_add_u32 v5, v9, v8
s_lshl_b32 s68, s40, 11
s_lshl_b32 s69, s39, 8
s_add_u32 s68, s68, s69
s_add_u32 s4, s68, 524288
s_lshl_b32 s68, s38, 3
s_add_u32 s68, s68, s36
s_lshl_b32 s68, s68, 13
s_add_u32 s5, s68, 524288
s_getreg_b32 s46, hwreg(HW_REG_XCC_ID, 0, 4)
s_waitcnt lgkmcnt(0)
s_add_u32 s44, s44, 1
s_xor_b32 s45, s44, 0xa5c3e1f0
s_and_b32 s45, s45, -16
s_or_b32 s46, s46, s45
v_mov_b32 v26, s44
v_mov_b32 v27, s46
v_mov_b32 v30, s44
v_mov_b32 v31, s45
s_setprio 2
s_barrier
ds_read_b128 v[60:63], v12 offset:0
ds_read_b128 v[64:67], v12 offset:64
ds_read_b128 v[68:71], v12 offset:128
ds_read_b128 v[72:75], v12 offset:192
ds_read_b64_tr_b16 v[76:77], v20 offset:0
ds_read_b64_tr_b16 v[78:79], v20 offset:512
ds_read_b64_tr_b16 v[80:81], v21 offset:0
ds_read_b64_tr_b16 v[82:83], v21 offset:512
ds_read_b64_tr_b16 v[84:85], v22 offset:0
ds_read_b64_tr_b16 v[86:87], v22 offset:512
ds_read_b64_tr_b16 v[88:89], v23 offset:0
ds_read_b64_tr_b16 v[90:91], v23 offset:512
ds_read_b64_tr_b16 v[92:93], v20 offset:4096
ds_read_b64_tr_b16 v[94:95], v20 offset:4608
s_waitcnt lgkmcnt(8)
v_mfma_f32_16x16x32_bf16 v[44:47], v[76:79], v[60:63], 0
ds_read_b64_tr_b16 v[96:97], v21 offset:4096
ds_read_b64_tr_b16 v[98:99], v21 offset:4608
s_waitcnt lgkmcnt(8)
v_mfma_f32_16x16x32_bf16 v[48:51], v[80:83], v[60:63], 0
ds_read_b64_tr_b16 v[100:101], v22 offset:4096
ds_read_b64_tr_b16 v[102:103], v22 offset:4608
s_waitcnt lgkmcnt(8)
v_mfma_f32_16x16x32_bf16 v[52:55], v[84:87], v[60:63], 0
ds_read_b64_tr_b16 v[104:105], v23 offset:4096
ds_read_b64_tr_b16 v[106:107], v23 offset:4608
s_waitcnt lgkmcnt(8)
v_mfma_f32_16x16x32_bf16 v[56:59], v[88:91], v[60:63], 0
ds_read_b64_tr_b16 v[108:109], v20 offset:8192
ds_read_b64_tr_b16 v[110:111], v20 offset:8704
s_waitcnt lgkmcnt(8)
v_mfma_f32_16x16x32_bf16 v[44:47], v[92:95], v[64:67], v[44:47]
ds_read_b64_tr_b16 v[112:113], v21 offset:8192
ds_read_b64_tr_b16 v[114:115], v21 offset:8704
s_waitcnt lgkmcnt(8)
v_mfma_f32_16x16x32_bf16 v[48:51], v[96:99], v[64:67], v[48:51]
ds_read_b64_tr_b16 v[116:117], v22 offset:8192
ds_read_b64_tr_b16 v[118:119], v22 offset:8704
s_waitcnt lgkmcnt(8)
v_mfma_f32_16x16x32_bf16 v[52:55], v[100:103], v[64:67], v[52:55]
ds_read_b64_tr_b16 v[120:121], v23 offset:8192
ds_read_b64_tr_b16 v[122:123], v23 offset:8704
s_waitcnt lgkmcnt(8)
v_mfma_f32_16x16x32_bf16 v[56:59], v[104:107], v[64:67], v[56:59]
ds_read_b64_tr_b16 v[124:125], v20 offset:12288
ds_read_b64_tr_b16 v[126:127], v20 offset:12800
s_waitcnt lgkmcnt(8)
v_mfma_f32_16x16x32_bf16 v[44:47], v[108:111], v[68:71], v[44:47]
ds_read_b64_tr_b16 v[128:129], v21 offset:12288
ds_read_b64_tr_b16 v[130:131], v21 offset:12800
s_waitcnt lgkmcnt(8)
v_mfma_f32_16x16x32_bf16 v[48:51], v[112:115], v[68:71], v[48:51]
ds_read_b64_tr_b16 v[132:133], v22 offset:12288
ds_read_b64_tr_b16 v[134:135], v22 offset:12800
s_waitcnt lgkmcnt(8)
v_mfma_f32_16x16x32_bf16 v[52:55], v[116:119], v[68:71], v[52:55]
ds_read_b64_tr_b16 v[136:137], v23 offset:12288
ds_read_b64_tr_b16 v[138:139], v23 offset:12800
s_waitcnt lgkmcnt(8)
v_mfma_f32_16x16x32_bf16 v[56:59], v[120:123], v[68:71], v[56:59]
s_waitcnt lgkmcnt(6)
v_mfma_f32_16x16x32_bf16 v[44:47], v[124:127], v[72:75], v[44:47]
s_waitcnt lgkmcnt(4)
v_mfma_f32_16x16x32_bf16 v[48:51], v[128:131], v[72:75], v[48:51]
s_waitcnt lgkmcnt(2)
v_mfma_f32_16x16x32_bf16 v[52:55], v[132:135], v[72:75], v[52:55]
s_waitcnt lgkmcnt(0)
v_mfma_f32_16x16x32_bf16 v[56:59], v[136:139], v[72:75], v[56:59]
s_nop 1
v_cvt_pk_bf16_f32 v32, v44, v45
v_cvt_pk_bf16_f32 v33, v46, v47
v_cvt_pk_bf16_f32 v34, v48, v49
v_cvt_pk_bf16_f32 v35, v50, v51
v_cvt_pk_bf16_f32 v36, v52, v53
v_cvt_pk_bf16_f32 v37, v54, v55
v_cvt_pk_bf16_f32 v38, v56, v57
v_cvt_pk_bf16_f32 v39, v58, v59
v_mov_b32_dpp v24, v32 quad_perm:[0,1,2,3] row_mask:0xf bank_mask:0x1
v_mov_b32_dpp v25, v33 quad_perm:[0,1,2,3] row_mask:0xf bank_mask:0x1
s_nop 0
v_mov_b32_dpp v24, v34 quad_perm:[0,1,2,3] row_mask:0xf bank_mask:0x2
v_mov_b32_dpp v25, v35 quad_perm:[0,1,2,3] row_mask:0xf bank_mask:0x2
s_nop 0
v_mov_b32_dpp v24, v36 quad_perm:[0,1,2,3] row_mask:0xf bank_mask:0x4
v_mov_b32_dpp v25, v37 quad_perm:[0,1,2,3] row_mask:0xf bank_mask:0x4
s_nop 0
v_mov_b32_dpp v24, v38 quad_perm:[0,1,2,3] row_mask:0xf bank_mask:0x8
v_mov_b32_dpp v25, v39 quad_perm:[0,1,2,3] row_mask:0xf bank_mask:0x8
buffer_store_dwordx4 v[24:27], v19, s[48:51], s4 offen
s_cmp_eq_u32 s39, 7
s_cbranch_scc1 L_NOW1
buffer_load_dwordx4 v43, s[56:59], s41 offen nt lds
s_add_u32 m0, m0, 1024
s_add_u32 s41, s41, 57344
buffer_load_dwordx4 v43, s[56:59], s41 offen nt lds
s_add_u32 m0, m0, 1024
s_add_u32 s41, s41, 57344
buffer_load_dwordx4 v43, s[56:59], s41 offen nt lds
s_add_u32 m0, m0, 1024
s_add_u32 s41, s41, 57344
buffer_load_dwordx4 v43, s[56:59], s41 offen nt lds
s_add_u32 m0, m0, 1024
s_add_u32 s41, s41, 57344
buffer_load_dwordx4 v43, s[56:59], s41 offen nt lds
s_add_u32 m0, m0, 1024
s_add_u32 s41, s41, 57344
buffer_load_dwordx4 v43, s[56:59], s41 offen nt lds
s_add_u32 m0, m0, 1024
s_add_u32 s41, s41, 57344
buffer_load_dwordx4 v43, s[56:59], s41 offen nt lds
s_add_u32 m0, m0, 1024
s_add_u32 s41, s41, 57344
buffer_load_dwordx4 v43, s[56:59], s41 offen nt lds
L_NOW1:
s_mov_b32 m0, 151552
s_nop 0
buffer_load_dwordx4 v6, s[64:67], 0 offen  lds
global_load_dwordx2 v[14:15], v208, s[22:23]
global_load_dwordx2 v[210:211], v40, s[26:27]
s_lshl_b32 s69, s42, 10
v_add_u32 v40, s69, v40
s_waitcnt vmcnt(0)
ds_read_b128 v[76:79], v13 offset:0
ds_read_b128 v[108:111], v11 offset:0
ds_read_b128 v[80:83], v13 offset:64
ds_read_b128 v[112:115], v11 offset:64
ds_read_b128 v[84:87], v13 offset:128
ds_read_b128 v[116:119], v11 offset:128
ds_read_b128 v[88:91], v13 offset:192
ds_read_b128 v[120:123], v11 offset:192
ds_read_b128 v[92:95], v13 offset:256
ds_read_b128 v[124:127], v11 offset:256
ds_read_b128 v[96:99], v13 offset:320
ds_read_b128 v[128:131], v11 offset:320
s_waitcnt lgkmcnt(10)
v_mfma_f32_16x16x32_bf16 v[44:47], v[76:79], v[108:111], 0
ds_read_b128 v[76:79], v13 offset:384
ds_read_b128 v[108:111], v11 offset:384
s_waitcnt lgkmcnt(10)
v_mfma_f32_16x16x32_bf16 v[44:47], v[80:83], v[112:115], v[44:47]
ds_read_b128 v[80:83], v13 offset:448
ds_read_b128 v[112:115], v11 offset:448
s_waitcnt lgkmcnt(10)
v_mfma_f32_16x16x32_bf16 v[44:47], v[84:87], v[116:119], v[44:47]
ds_read_b128 v[84:87], v13 offset:512
ds_read_b128 v[116:119], v11 offset:512
s_waitcnt lgkmcnt(10)
v_mfma_f32_16x16x32_bf16 v[44:47], v[88:91], v[120:123], v[44:47]
ds_read_b128 v[88:91], v13 offset:576
ds_read_b128 v[120:123], v11 offset:576
s_waitcnt lgkmcnt(10)
v_mfma_f32_16x16x32_bf16 v[44:47], v[92:95], v[124:127], v[44:47]
ds_read_b128 v[92:95], v13 offset:640
ds_read_b128 v[124:127], v11 offset:640
s_waitcnt lgkmcnt(10)
v_mfma_f32_16x16x32_bf16 v[44:47], v[96:99], v[128:131], v[44:47]
ds_read_b128 v[96:99], v13 offset:704
ds_read_b128 v[128:131], v11 offset:704
s_waitcnt lgkmcnt(10)
v_mfma_f32_16x16x32_bf16 v[44:47], v[76:79], v[108:111], v[44:47]
ds_read_b128 v[76:79], v13 offset:768
ds_read_b128 v[108:111], v11 offset:768
s_waitcnt lgkmcnt(10)
v_mfma_f32_16x16x32_bf16 v[44:47], v[80:83], v[112:115], v[44:47]
ds_read_b128 v[80:83], v13 offset:832
ds_read_b128 v[112:115], v11 offset:832
s_waitcnt lgkmcnt(10)
v_mfma_f32_16x16x32_bf16 v[44:47], v[84:87], v[116:119], v[44:47]
ds_read_b128 v[84:87], v13 offset:896
ds_read_b128 v[116:119], v11 offset:896
s_waitcnt lgkmcnt(10)
v_mfma_f32_16x16x32_bf16 v[44:47], v[88:91], v[120:123], v[44:47]
ds_read_b128 v[88:91], v13 offset:960
ds_read_b128 v[120:123], v11 offset:960
s_waitcnt lgkmcnt(10)
v_mfma_f32_16x16x32_bf16 v[44:47], v[92:95], v[124:127], v[44:47]
s_waitcnt lgkmcnt(8)
v_mfma_f32_16x16x32_bf16 v[44:47], v[96:99], v[128:131], v[44:47]
s_waitcnt lgkmcnt(6)
v_mfma_f32_16x16x32_bf16 v[44:47], v[76:79], v[108:111], v[44:47]
s_waitcnt lgkmcnt(4)
v_mfma_f32_16x16x32_bf16 v[44:47], v[80:83], v[112:115], v[44:47]
s_waitcnt lgkmcnt(2)
v_mfma_f32_16x16x32_bf16 v[44:47], v[84:87], v[116:119], v[44:47]
s_waitcnt lgkmcnt(0)
v_mfma_f32_16x16x32_bf16 v[44:47], v[88:91], v[120:123], v[44:47]
s_nop 7
v_mul_f32 v8, 0xbfb8aa3b, v44
v_exp_f32 v8, v8
s_nop 0
v_add_f32 v8, 1.0, v8
v_rcp_f32 v18, v8
s_nop 0
v_sub_f32 v17, 1.0, v18
v_lshlrev_b32 v8, 2, v2
v_add_u32 v8, 153664, v8
s_mov_b64 exec, 15
ds_write_b32 v8, v17
s_mov_b64 exec, -1
s_waitcnt lgkmcnt(0)
ds_read_b64_tr_b16 v[76:77], v41 offset:0
ds_read_b64_tr_b16 v[78:79], v41 offset:256
ds_read_b64_tr_b16 v[80:81], v41 offset:32
ds_read_b64_tr_b16 v[82:83], v41 offset:288
ds_read_b64_tr_b16 v[84:85], v41 offset:2048
ds_read_b64_tr_b16 v[86:87], v41 offset:2304
ds_read_b64_tr_b16 v[88:89], v41 offset:2080
ds_read_b64_tr_b16 v[90:91], v41 offset:2336
ds_read_b64_tr_b16 v[92:93], v41 offset:4096
ds_read_b64_tr_b16 v[94:95], v41 offset:4352
s_waitcnt lgkmcnt(8)
v_mfma_f32_16x16x32_bf16 v[44:47], v[76:79], v[60:63], 0
ds_read_b64_tr_b16 v[96:97], v41 offset:4128
ds_read_b64_tr_b16 v[98:99], v41 offset:4384
s_waitcnt lgkmcnt(8)
v_mfma_f32_16x16x32_bf16 v[48:51], v[80:83], v[60:63], 0
ds_read_b64_tr_b16 v[100:101], v41 offset:6144
ds_read_b64_tr_b16 v[102:103], v41 offset:6400
s_waitcnt lgkmcnt(8)
v_mfma_f32_16x16x32_bf16 v[44:47], v[84:87], v[64:67], v[44:47]
ds_read_b64_tr_b16 v[104:105], v41 offset:6176
ds_read_b64_tr_b16 v[106:107], v41 offset:6432
s_waitcnt lgkmcnt(8)
v_mfma_f32_16x16x32_bf16 v[48:51], v[88:91], v[64:67], v[48:51]
s_waitcnt lgkmcnt(6)
v_mfma_f32_16x16x32_bf16 v[44:47], v[92:95], v[68:71], v[44:47]
s_waitcnt lgkmcnt(4)
v_mfma_f32_16x16x32_bf16 v[48:51], v[96:99], v[68:71], v[48:51]
s_waitcnt lgkmcnt(2)
v_mfma_f32_16x16x32_bf16 v[44:47], v[100:103], v[72:75], v[44:47]
s_waitcnt lgkmcnt(0)
v_mfma_f32_16x16x32_bf16 v[48:51], v[104:107], v[72:75], v[48:51]
s_nop 5
v_cvt_pk_bf16_f32 v32, v44, v45
v_cvt_pk_bf16_f32 v33, v46, v47
v_cvt_pk_bf16_f32 v34, v48, v49
v_cvt_pk_bf16_f32 v35, v50, v51
v_mov_b32_dpp v28, v32 quad_perm:[0,1,2,3] row_mask:0xf bank_mask:0x1
v_mov_b32_dpp v29, v33 quad_perm:[0,1,2,3] row_mask:0xf bank_mask:0x1
s_nop 0
v_mov_b32_dpp v28, v34 quad_perm:[0,1,2,3] row_mask:0xf bank_mask:0x2
v_mov_b32_dpp v29, v35 quad_perm:[0,1,2,3] row_mask:0xf bank_mask:0x2
v_lshlrev_b32 v9, 3, v2
v_add_u32 v9, 152576, v9
s_mov_b32 s70, 2000000
s_mov_b32 s47, 0
s_add_u32 s71, s4, 262144
QP_LOOP:
s_add_u32 s6, s5, 4096
buffer_load_dwordx4 v[144:147], v6, s[48:51], s5 offen offset:0 sc1
buffer_load_dwordx4 v[148:151], v6, s[48:51], s5 offen offset:1024 sc1
buffer_load_dwordx4 v[152:155], v6, s[48:51], s5 offen offset:2048 sc1
buffer_load_dwordx4 v[156:159], v6, s[48:51], s5 offen offset:3072 sc1
buffer_load_dwordx4 v[160:163], v6, s[48:51], s6 offen offset:0 sc1
buffer_load_dwordx4 v[164:167], v6, s[48:51], s6 offen offset:1024 sc1
buffer_load_dwordx4 v[168:171], v6, s[48:51], s6 offen offset:2048 sc1
buffer_load_dwordx4 v[172:175], v6, s[48:51], s6 offen offset:3072 sc1
s_waitcnt vmcnt(0)
v_xor_b32 v8, s44, v146
v_xor_b32 v10, s46, v147
v_bitop3_b32 v8, v150, s44, v8 bitop3:0xbe
v_bitop3_b32 v10, v151, s46, v10 bitop3:0xbe
v_bitop3_b32 v8, v154, s44, v8 bitop3:0xbe
v_bitop3_b32 v10, v155, s46, v10 bitop3:0xbe
v_bitop3_b32 v8, v158, s44, v8 bitop3:0xbe
v_bitop3_b32 v10, v159, s46, v10 bitop3:0xbe
v_bitop3_b32 v8, v162, s44, v8 bitop3:0xbe
v_bitop3_b32 v10, v163, s46, v10 bitop3:0xbe
v_bitop3_b32 v8, v166, s44, v8 bitop3:0xbe
v_bitop3_b32 v10, v167, s46, v10 bitop3:0xbe
v_bitop3_b32 v8, v170, s44, v8 bitop3:0xbe
v_bitop3_b32 v10, v171, s46, v10 bitop3:0xbe
v_bitop3_b32 v8, v174, s44, v8 bitop3:0xbe
v_bitop3_b32 v10, v175, s46, v10 bitop3:0xbe
v_and_or_b32 v8, v10, -16, v8
v_cmp_ne_u32 vcc, 0, v8
s_nop 0
s_cmp_eq_u64 vcc, 0
s_cbranch_scc1 QP_OK
s_sub_u32 s70, s70, 1
s_cbranch_scc1 QP_OK
s_cmp_gt_u32 s70, 1999996
s_cbranch_scc1 QP_AGAIN
s_cmp_lg_u32 s47, 0
s_cbranch_scc1 QP_FLIP
s_mov_b32 s47, 1
buffer_store_dwordx4 v[24:27], v19, s[48:51], s71 offen sc1
QP_FLIP:
s_xor_b32 s5, s5, 0x40000
QP_AGAIN:
s_sleep 2
s_branch QP_LOOP
QP_OK:
v_cmp_ne_u32 vcc, 0, v10
s_nop 0
s_cmp_eq_u64 vcc, 0
s_cselect_b32 s29, 1, 0
v_lshlrev_b32 v76, 16, v144
v_and_b32 v77, 0xffff0000, v144
v_lshlrev_b32 v78, 16, v145
v_and_b32 v79, 0xffff0000, v145
v_lshlrev_b32 v80, 16, v152
v_and_b32 v81, 0xffff0000, v152
v_lshlrev_b32 v82, 16, v153
v_and_b32 v83, 0xffff0000, v153
v_add_f32 v76, v76, v80
v_add_f32 v77, v77, v81
v_add_f32 v78, v78, v82
v_add_f32 v79, v79, v83
v_lshlrev_b32 v80, 16, v160
v_and_b32 v81, 0xffff0000, v160
v_lshlrev_b32 v82, 16, v161
v_and_b32 v83, 0xffff0000, v161
v_add_f32 v76, v76, v80
v_add_f32 v77, v77, v81
v_add_f32 v78, v78, v82
v_add_f32 v79, v79, v83
v_lshlrev_b32 v80, 16, v168
v_and_b32 v81, 0xffff0000, v168
v_lshlrev_b32 v82, 16, v169
v_and_b32 v83, 0xffff0000, v169
v_add_f32 v76, v76, v80
v_add_f32 v77, v77, v81
v_add_f32 v78, v78, v82
v_add_f32 v79, v79, v83
v_cvt_pk_bf16_f32 v76, v76, v77
v_cvt_pk_bf16_f32 v77, v78, v79
ds_write_b64 v9, v[76:77] offset:0
v_lshlrev_b32 v76, 16, v148
v_and_b32 v77, 0xffff0000, v148
v_lshlrev_b32 v78, 16, v149
v_and_b32 v79, 0xffff0000, v149
v_lshlrev_b32 v80, 16, v156
v_and_b32 v81, 0xffff0000, v156
v_lshlrev_b32 v82, 16, v157
v_and_b32 v83, 0xffff0000, v157
v_add_f32 v76, v76, v80
v_add_f32 v77, v77, v81
v_add_f32 v78, v78, v82
v_add_f32 v79, v79, v83
v_lshlrev_b32 v80, 16, v164
v_and_b32 v81, 0xffff0000, v164
v_lshlrev_b32 v82, 16, v165
v_and_b32 v83, 0xffff0000, v165
v_add_f32 v76, v76, v80
v_add_f32 v77, v77, v81
v_add_f32 v78, v78, v82
v_add_f32 v79, v79, v83
v_lshlrev_b32 v80, 16, v172
v_and_b32 v81, 0xffff0000, v172
v_lshlrev_b32 v82, 16, v173
v_and_b32 v83, 0xffff0000, v173
v_add_f32 v76, v76, v80
v_add_f32 v77, v77, v81
v_add_f32 v78, v78, v82
v_add_f32 v79, v79, v83
v_cvt_pk_bf16_f32 v76, v76, v77
v_cvt_pk_bf16_f32 v77, v78, v79
ds_write_b64 v9, v[76:77] offset:512
s_add_u32 s68, s29, 1
v_mov_b32 v8, 154368
v_mov_b32 v10, s68
ds_write_b32 v8, v10 offset:8
s_setprio 0
s_or_b32 s68, s47, s29
s_cbranch_scc1 QP_NOB
buffer_store_dwordx4 v[24:27], v19, s[48:51], s71 offen sc1
QP_NOB:
s_cmp_eq_u32 s39, 7
s_cbranch_scc1 L_NOH
s_mul_i32 s68, s40, 3584
s_lshl_b32 s69, s39, 7
s_add_u32 s68, s68, s69
s_add_u32 s71, s68, 65536
s_mov_b32 exec_lo, 0x00ff00ff
s_mov_b32 exec_hi, 0x00ff00ff
s_cmp_lg_u32 s29, 0
s_cbranch_scc1 PUB114_L
buffer_store_dwordx4 v[28:31], v5, s[48:51], s71 offen sc1
s_branch PUB114_E
PUB114_L:
buffer_store_dwordx4 v[28:31], v5, s[48:51], s71 offen
PUB114_E:
s_mov_b64 exec, -1
L_NOH:
s_nop 0
v_readlane_b32 s75, v17, s42
v_readlane_b32 s43, v18, s38
s_lshl_b32 s69, s40, 9
s_add_u32 s6, s69, 32768
s_lshl_b32 s69, s39, 6
s_add_u32 s71, s6, s69
s_mov_b32 s70, 8000000
v_mov_b32 v8, 154368
LW_a:
ds_read_b32 v9, v8 offset:0
s_waitcnt lgkmcnt(0)
v_readfirstlane_b32 s68, v9
s_nop 0
s_cmp_ge_u32 s68, 4
s_cbranch_scc1 LW_a_OK
s_sub_u32 s70, s70, 1
s_cbranch_scc1 LW_a_OK
s_sleep 4
s_branch LW_a
LW_a_OK:
v_lshlrev_b32 v8, 3, v4
v_add_u32 v8, 154240, v8
ds_read_b64 v[32:33], v8
s_waitcnt lgkmcnt(0)
v_max_f32_dpp v28, v32, v32 row_ror:4 row_mask:0xf bank_mask:0xf
s_nop 1
v_max_f32_dpp v28, v28, v28 row_ror:8 row_mask:0xf bank_mask:0xf
v_sub_f32 v8, v32, v28
v_exp_f32 v8, v8
s_nop 0
v_mul_f32 v29, v8, v33
s_nop 1
v_add_f32_dpp v29, v29, v29 row_ror:4 row_mask:0xf bank_mask:0xf
s_nop 1
v_add_f32_dpp v29, v29, v29 row_ror:8 row_mask:0xf bank_mask:0xf
s_mov_b64 exec, 15
s_cmp_lg_u32 s29, 0
s_cbranch_scc1 PUB115_L
buffer_store_dwordx4 v[28:31], v6, s[48:51], s71 offen sc1
s_branch PUB115_E
PUB115_L:
buffer_store_dwordx4 v[28:31], v6, s[48:51], s71 offen
PUB115_E:
s_mov_b64 exec, -1
v_mul_u32_u24 v8, 896, v3
v_lshl_add_u32 v8, v42, 4, v8
s_mul_i32 s56, s36, 14336
s_mul_i32 s69, s38, 224
s_add_u32 s56, s56, s69
s_add_u32 s56, s56, 65536
s_add_u32 s57, s56, 3584
s_add_u32 s58, s57, 3584
s_add_u32 s59, s58, 3584
s_mov_b32 s70, 2000000
POLL_h:
buffer_load_dwordx4 v[144:147], v8, s[48:51], s56 offen sc1
buffer_load_dwordx4 v[148:151], v8, s[48:51], s57 offen sc1
buffer_load_dwordx4 v[152:155], v8, s[48:51], s58 offen sc1
buffer_load_dwordx4 v[156:159], v8, s[48:51], s59 offen sc1
POLL_h_CHK:
s_waitcnt vmcnt(0)
v_cmp_ne_u64 vcc, s[44:45], v[146:147]
v_cmp_ne_u64 s[72:73], s[44:45], v[150:151]
v_cmp_ne_u64 s[8:9], s[44:45], v[154:155]
v_cmp_ne_u64 s[10:11], s[44:45], v[158:159]
s_or_b64 s[72:73], s[72:73], vcc
s_or_b64 s[8:9], s[8:9], s[10:11]
s_or_b64 s[72:73], s[72:73], s[8:9]
s_cbranch_scc0 POLL_h_OK
s_sub_u32 s70, s70, 1
s_cbranch_scc1 POLL_h_OK
s_sleep 2
s_branch POLL_h
POLL_h_OK:
v_lshlrev_b32 v76, 16, v144
v_and_b32 v77, 0xffff0000, v144
v_lshlrev_b32 v78, 16, v145
v_and_b32 v79, 0xffff0000, v145
v_lshlrev_b32 v80, 16, v148
v_and_b32 v81, 0xffff0000, v148
v_lshlrev_b32 v82, 16, v149
v_and_b32 v83, 0xffff0000, v149
v_add_f32 v76, v76, v80
v_add_f32 v77, v77, v81
v_add_f32 v78, v78, v82
v_add_f32 v79, v79, v83
v_lshlrev_b32 v80, 16, v152
v_and_b32 v81, 0xffff0000, v152
v_lshlrev_b32 v82, 16, v153
v_and_b32 v83, 0xffff0000, v153
v_add_f32 v76, v76, v80
v_add_f32 v77, v77, v81
v_add_f32 v78, v78, v82
v_add_f32 v79, v79, v83
v_lshlrev_b32 v80, 16, v156
v_and_b32 v81, 0xffff0000, v156
v_lshlrev_b32 v82, 16, v157
v_and_b32 v83, 0xffff0000, v157
v_add_f32 v76, v76, v80
v_add_f32 v77, v77, v81
v_add_f32 v78, v78, v82
v_add_f32 v79, v79, v83
v_lshlrev_b32 v80, 16, v14
v_and_b32 v81, 0xffff0000, v14
v_lshlrev_b32 v82, 16, v15
v_and_b32 v83, 0xffff0000, v15
v_add_f32 v76, v76, v80
v_add_f32 v77, v77, v81
v_add_f32 v78, v78, v82
v_add_f32 v79, v79, v83
s_mov_b32 s68, 0xbdd2d3e8
v_mov_b32 v8, 0xc0135761
v_mul_f32 v80, v76, v76
v_mul_f32 v81, v77, v77
v_mul_f32 v82, v78, v78
v_mul_f32 v83, v79, v79
v_fma_f32 v80, v80, s68, v8
v_fma_f32 v81, v81, s68, v8
v_fma_f32 v82, v82, s68, v8
v_fma_f32 v83, v83, s68, v8
v_mul_f32 v80, v80, v76
v_mul_f32 v81, v81, v77
v_mul_f32 v82, v82, v78
v_mul_f32 v83, v83, v79
v_exp_f32 v80, v80
v_exp_f32 v81, v81
v_exp_f32 v82, v82
v_exp_f32 v83, v83
v_add_f32 v80, 1.0, v80
v_add_f32 v81, 1.0, v81
v_add_f32 v82, 1.0, v82
v_add_f32 v83, 1.0, v83
v_rcp_f32 v80, v80
v_rcp_f32 v81, v81
v_rcp_f32 v82, v82
v_rcp_f32 v83, v83
v_mul_f32 v76, v76, v80
v_mul_f32 v77, v77, v81
v_mul_f32 v78, v78, v82
v_mul_f32 v79, v79, v83
v_cvt_pk_bf16_f32 v144, v76, v77
v_cvt_pk_bf16_f32 v145, v78, v79
s_mov_b32 exec_lo, 0xc000c000
s_mov_b32 exec_hi, 0xc000c000
v_mov_b32 v144, 0
v_mov_b32 v145, 0
s_mov_b64 exec, -1
v_lshlrev_b32 v8, 3, v2
v_add_u32 v8, 153728, v8
ds_write_b64 v8, v[144:145]
v_and_b32 v10, 0x1f0, v6
s_mov_b32 s70, 8000000
v_mov_b32 v8, 154368
LW_b:
ds_read_b32 v9, v8 offset:4
s_waitcnt lgkmcnt(0)
v_readfirstlane_b32 s68, v9
s_nop 0
s_cmp_ge_u32 s68, 1
s_cbranch_scc1 LW_b_OK
s_sub_u32 s70, s70, 1
s_cbranch_scc1 LW_b_OK
s_sleep 4
s_branch LW_b
LW_b_OK:
s_mov_b32 s70, 2000000
POLL_ml:
buffer_load_dwordx4 v[144:147], v10, s[48:51], s6 offen sc1
POLL_ml_CHK:
s_waitcnt vmcnt(0)
v_cmp_ne_u64 vcc, s[44:45], v[146:147]
s_nop 1
s_cbranch_vccz POLL_ml_OK
s_sub_u32 s70, s70, 1
s_cbranch_scc1 POLL_ml_OK
s_sleep 4
s_branch POLL_ml
POLL_ml_OK:
v_mov_b32 v8, v144
s_nop 1
v_max_f32_dpp v8, v8, v8 row_ror:4 row_mask:0xf bank_mask:0xf
s_nop 1
v_max_f32_dpp v8, v8, v8 row_ror:8 row_mask:0xf bank_mask:0xf
v_mov_b32 v9, v8
s_nop 1
v_permlane16_swap_b32 v8, v9
v_max_f32 v8, v8, v9
v_sub_f32 v144, v144, v8
v_sub_f32 v32, v32, v8
v_exp_f32 v144, v144
v_exp_f32 v32, v32
v_mul_f32 v8, v144, v145
s_nop 1
v_add_f32_dpp v8, v8, v8 row_ror:4 row_mask:0xf bank_mask:0xf
s_nop 1
v_add_f32_dpp v8, v8, v8 row_ror:8 row_mask:0xf bank_mask:0xf
v_mov_b32 v9, v8
s_nop 1
v_permlane16_swap_b32 v8, v9
v_add_f32 v8, v8, v9
v_rcp_f32 v8, v8
v_mul_f32 v32, s43, v32
v_mul_f32 v32, v32, v8
v_bfe_u32 v8, v2, 2, 2
v_lshlrev_b32 v8, 2, v8
v_lshl_add_u32 v8, v7, 4, v8
v_add_u32 v8, 153600, v8
ds_write_b32 v8, v32
v_lshrrev_b32 v8, 1, v2
v_lshlrev_b32 v8, 13, v8
v_and_b32 v9, 1, v2
v_lshl_add_u32 v8, v9, 4, v8
s_lshl_b32 s68, s36, 10
s_lshl_b32 s69, s37, 5
s_add_u32 s68, s68, s69
s_add_u32 s5, s68, 1572864
v_and_b32 v9, 1, v2
v_lshlrev_b32 v9, 4, v9
v_mov_b32 v10, 0x3f80
v_lshlrev_b32 v9, v9, v10
v_lshrrev_b32 v10, 1, v4
v_cmp_eq_u32 vcc, 0, v10
s_nop 1
v_cndmask_b32 v60, 0, v9, vcc
v_cmp_eq_u32 vcc, 1, v10
s_nop 1
v_cndmask_b32 v61, 0, v9, vcc
v_lshlrev_b32 v76, 16, v210
v_and_b32 v77, 0xffff0000, v210
v_lshlrev_b32 v78, 16, v211
v_and_b32 v79, 0xffff0000, v211
v_mul_f32 v76, s75, v76
v_mul_f32 v77, s75, v77
v_mul_f32 v78, s75, v78
v_mul_f32 v79, s75, v79
s_waitcnt lgkmcnt(0)
s_barrier
s_barrier
s_barrier
s_mov_b32 s70, 2000000
POLL_p3:
buffer_load_dwordx4 v[144:147], v8, s[48:51], s5 offen sc1
POLL_p3_CHK:
s_waitcnt vmcnt(0)
v_cmp_ne_u64 vcc, s[44:45], v[146:147]
s_nop 1
s_cbranch_vccz POLL_p3_OK
s_sub_u32 s70, s70, 1
s_cbranch_scc1 POLL_p3_OK
s_branch POLL_p3
POLL_p3_OK:
v_mfma_f32_16x16x16_bf16 v[148:151], v[60:61], v[144:145], 0
s_nop 7
v_add_f32_dpp v148, v148, v148 quad_perm:[2,3,0,1] row_mask:0xf bank_mask:0xf
v_add_f32_dpp v149, v149, v149 quad_perm:[2,3,0,1] row_mask:0xf bank_mask:0xf
v_add_f32_dpp v150, v150, v150 quad_perm:[2,3,0,1] row_mask:0xf bank_mask:0xf
v_add_f32_dpp v151, v151, v151 quad_perm:[2,3,0,1] row_mask:0xf bank_mask:0xf
v_add_f32_dpp v148, v148, v148 row_ror:4 row_mask:0xf bank_mask:0xf
v_add_f32_dpp v149, v149, v149 row_ror:4 row_mask:0xf bank_mask:0xf
v_add_f32_dpp v150, v150, v150 row_ror:4 row_mask:0xf bank_mask:0xf
v_add_f32_dpp v151, v151, v151 row_ror:4 row_mask:0xf bank_mask:0xf
v_add_f32_dpp v148, v148, v148 row_ror:8 row_mask:0xf bank_mask:0xf
v_add_f32_dpp v149, v149, v149 row_ror:8 row_mask:0xf bank_mask:0xf
v_add_f32_dpp v150, v150, v150 row_ror:8 row_mask:0xf bank_mask:0xf
v_add_f32_dpp v151, v151, v151 row_ror:8 row_mask:0xf bank_mask:0xf
v_add_f32 v148, v148, v76
v_add_f32 v149, v149, v77
v_add_f32 v150, v150, v78
v_add_f32 v151, v151, v79
v_cvt_pk_bf16_f32 v144, v148, v149
v_cvt_pk_bf16_f32 v145, v150, v151
s_mov_b64 exec, 3
global_store_dwordx2 v40, v[144:145], s[30:31] sc1
s_cmp_lg_u32 s2, 0
s_cbranch_scc1 L_HEND
s_mov_b64 exec, 1
v_mov_b32 v8, 0
buffer_store_dword v30, v8, s[48:51], 0 offen sc1
L_HEND:
s_endpgm
L_END:
s_endpgm
.section .rodata,"a"
.p2align 6
.amdhsa_kernel gated_mix__gqa_block_cached__dense_activation_gelu__decode_kernel
  .amdhsa_next_free_vgpr 240
  .amdhsa_next_free_sgpr 96
  .amdhsa_accum_offset 240
  .amdhsa_group_segment_fixed_size 0
  .amdhsa_kernarg_size 112
  .amdhsa_user_sgpr_count 2
  .amdhsa_user_sgpr_kernarg_segment_ptr 1
  .amdhsa_system_sgpr_workgroup_id_x 1
.end_amdhsa_kernel
```
